```python
import torch

def _softmax(x, axis=-1):
    return torch.softmax(x, dim=axis)
def _gelu(x):
    return torch.nn.functional.gelu(x, approximate="tanh")
def _silu(x):
    return torch.nn.functional.silu(x)
def _sigmoid(x):
    return torch.sigmoid(x)
def _layernorm(x, axis=-1, eps=1e-5):
    m = x.mean(dim=axis, keepdim=True)
    v = x.var(dim=axis, keepdim=True, unbiased=False)
    return (x - m) / torch.sqrt(v + eps)
def _scatter_add(tgt, idx, src, axis=0):
    return tgt.clone().index_add_(axis, idx, src)
def _segment_sum(src, seg, n):
    out = torch.zeros((n,) + src.shape[1:], dtype=src.dtype)
    return out.index_add_(0, seg, src)
def _pad(x, pw):
    flat = tuple(v for pair in reversed(pw) for v in pair)
    return torch.nn.functional.pad(x, flat)

kernel_name = 'recurrent_scan__spectral_fnet__swiglu_ffn__prompt'

def setup_inputs():

    _w = (lambda a: (lambda t: t.to(torch.bfloat16) if t.is_floating_point() else t)(torch.as_tensor(a)))
    def _A_setup():
        B, S, D = 1, 2048, 512
        ns = torch.arange(S)[:, None] * torch.arange(S)[None, :]
        nd = torch.arange(D)[:, None] * torch.arange(D)[None, :]
        Ws_re = torch.cos(-2.0 * torch.pi * ns / S).to(float)
        Ws_im = torch.sin(-2.0 * torch.pi * ns / S).to(float)
        Wd_re = torch.cos(-2.0 * torch.pi * nd / D).to(float)
        Wd_im = torch.sin(-2.0 * torch.pi * nd / D).to(float)
        return {
            "x": _w((lambda *s: torch.randn(*s, dtype=torch.bfloat16) * 0.05)(B, S, D)),
            "dft_seq_re": _w(Ws_re),
            "dft_seq_im": _w(Ws_im),
            "dft_hid_re": _w(Wd_re),
            "dft_hid_im": _w(Wd_im),
        }
    _A_in = _A_setup()

    def _B_setup():
        B, S, D, F = 1, 2048, 512, 1792
        return {
            "x": _w((lambda *s: torch.randn(*s, dtype=torch.bfloat16) * 0.05)(B, S, D)),
            "w_gate": _w((lambda *s: torch.randn(*s, dtype=torch.bfloat16) * 0.05)(D, F)),
            "w_up": _w((lambda *s: torch.randn(*s, dtype=torch.bfloat16) * 0.05)(D, F)),
            "w_down": _w((lambda *s: torch.randn(*s, dtype=torch.bfloat16) * 0.05)(F, D)),
        }
    _B_in = _B_setup()

    return {
        "A_x": _A_in["x"],
        "A_dft_seq_re": _A_in["dft_seq_re"],
        "A_dft_seq_im": _A_in["dft_seq_im"],
        "A_dft_hid_re": _A_in["dft_hid_re"],
        "A_dft_hid_im": _A_in["dft_hid_im"],
        "B_x": _B_in["x"],
        "B_w_gate": _B_in["w_gate"],
        "B_w_up": _B_in["w_up"],
        "B_w_down": _B_in["w_down"],
    }

def reference(A_x, A_dft_seq_re, A_dft_seq_im, A_dft_hid_re, A_dft_hid_im, B_x, B_w_gate, B_w_up, B_w_down):
    def _A_ref(x, dft_seq_re, dft_seq_im, dft_hid_re, dft_hid_im):
        a = torch.einsum("bsd,ed->bse", x, dft_hid_re)
        b = torch.einsum("bsd,ed->bse", x, dft_hid_im)
        y = torch.einsum("ts,bse->bte", dft_seq_re, a) - torch.einsum("ts,bse->bte", dft_seq_im, b)
        return y

    def _B_ref(x, w_gate, w_up, w_down):
        g = _silu(x @ w_gate)
        u = x @ w_up
        return (g * u) @ w_down

    x = A_x
    xn = _layernorm(x, axis=-1)
    s = _A_ref(xn, A_dft_seq_re, A_dft_seq_im, A_dft_hid_re, A_dft_hid_im)
    g = _silu(_B_ref(xn, B_w_gate, B_w_up, B_w_down))
    return x + s * g
```

```asm
; @launch grid=(256,1,1) block=(512,1,1) lds=163840
.amdgcn_target "amdgcn-amd-amdhsa--gfx950"
.text
.globl recurrent_scan__spectral_fnet__swiglu_ffn__prompt_kernel
.p2align 8
.type recurrent_scan__spectral_fnet__swiglu_ffn__prompt_kernel,@function
recurrent_scan__spectral_fnet__swiglu_ffn__prompt_kernel:
    s_cmp_ge_u32 s2, 256
    s_cbranch_scc1 L_end_1
    s_load_dwordx16 s[32:47], s[0:1], 0
    s_load_dwordx8 s[48:55], s[0:1], 64
    s_getpc_b64 s[60:61]
L_pc_here:
    s_bfe_u32 s62, s2, 0x30003
    v_lshl_add_u32 v1, v0, 3, s62
    v_lshlrev_b32 v1, 7, v1
    v_min_u32 v1, L_code_end-L_pc_here-4, v1
    global_load_dword v252, v1, s[60:61]
    v_lshrrev_b32 v1, 6, v0
    v_and_b32 v255, 63, v0
    v_readfirstlane_b32 s56, v1
    s_lshr_b32 s93, s2, 3
    s_and_b32 s100, s2, 1
    s_bfe_u32 s101, s2, 0x20001
    s_bfe_u32 s60, s2, 0x10002
    s_bfe_u32 s61, s2, 0x10001
    s_mul_i32 s62, s60, 7
    s_lshr_b32 s63, s2, 6
    s_lshl2_add_u32 s63, s61, s63
    s_and_b32 s64, s93, 3
    s_lshl2_add_u32 s65, s61, s64
    s_and_b32 s66, s93, 7
    s_cmp_ge_u32 s93, 24
    s_cselect_b32 s63, 3, s63
    s_cselect_b32 s66, s65, s66
    s_add_u32 s58, s62, s63
    s_lshl3_add_u32 s4, s100, s66
    s_lshl2_add_u32 s64, s100, s64
    s_lshl3_add_u32 s64, s61, s64
    s_add_u32 s60, s60, 14
    s_cmp_ge_u32 s93, 28
    s_cselect_b32 s58, s60, s58
    s_cselect_b32 s57, s64, s4
    s_mov_b32 s10, 2097152
    s_mov_b32 s11, 0x00020000
    s_cmp_ge_u32 s56, 4
    s_cbranch_scc1 L_ld_2
    s_cmp_eq_u32 s56, 3
    s_cbranch_scc1 L_r3_6
    s_cmp_lg_u32 s56, 0
    s_cbranch_scc1 L_r1_5
    s_cmp_ge_u32 s58, 14
    s_cbranch_scc1 L_r3_6
    s_and_b32 s61, s4, 3
    s_bfe_u32 s63, s4, 0x10002
    s_lshl1_add_u32 s63, s58, s63
    s_lshr_b32 s69, s4, 3
    s_mul_i32 s72, s61, 3584
    s_lshl_b32 s62, s63, 7
    s_add_u32 s72, s72, s62
    s_mov_b32 s73, 114688
    s_mov_b32 s66, 1835008
    s_mov_b32 s67, s11
    s_mov_b32 s87, 0
    v_lshrrev_b32 v1, 3, v255
    v_mul_u32_u24 v1, 14336, v1
    v_and_b32 v2, 7, v255
    v_lshl_add_u32 v1, v2, 4, v1
    s_cmp_eq_u32 s69, 1
    s_waitcnt lgkmcnt(0)
    s_cselect_b64 s[64:65], s[46:47], s[44:45]
    v_mov_b32 v128, 9535488
    global_load_dword v128, v128, s[54:55] sc1
    buffer_load_dwordx4 v[160:163], v1, s[64:67], s72 offen
    s_add_u32 s72, s72, s73
    buffer_load_dwordx4 v[164:167], v1, s[64:67], s72 offen
    s_add_u32 s72, s72, s73
    buffer_load_dwordx4 v[168:171], v1, s[64:67], s72 offen
    s_add_u32 s72, s72, s73
    buffer_load_dwordx4 v[172:175], v1, s[64:67], s72 offen
    s_add_u32 s72, s72, s73
    buffer_load_dwordx4 v[176:179], v1, s[64:67], s72 offen
    s_add_u32 s72, s72, s73
    buffer_load_dwordx4 v[180:183], v1, s[64:67], s72 offen
    s_add_u32 s72, s72, s73
    buffer_load_dwordx4 v[184:187], v1, s[64:67], s72 offen
    s_add_u32 s72, s72, s73
    buffer_load_dwordx4 v[188:191], v1, s[64:67], s72 offen
    s_add_u32 s72, s72, s73
    buffer_load_dwordx4 v[192:195], v1, s[64:67], s72 offen
    s_add_u32 s72, s72, s73
    buffer_load_dwordx4 v[196:199], v1, s[64:67], s72 offen
    s_add_u32 s72, s72, s73
    buffer_load_dwordx4 v[200:203], v1, s[64:67], s72 offen
    s_add_u32 s72, s72, s73
    buffer_load_dwordx4 v[204:207], v1, s[64:67], s72 offen
    s_add_u32 s72, s72, s73
    buffer_load_dwordx4 v[208:211], v1, s[64:67], s72 offen
    s_add_u32 s72, s72, s73
    buffer_load_dwordx4 v[212:215], v1, s[64:67], s72 offen
    s_add_u32 s72, s72, s73
    buffer_load_dwordx4 v[216:219], v1, s[64:67], s72 offen
    s_add_u32 s72, s72, s73
    buffer_load_dwordx4 v[220:223], v1, s[64:67], s72 offen
    s_branch L_rt_8
L_r1_5:
    s_and_b32 s71, s93, 7
    s_lshr_b32 s70, s93, 3
    s_lshl2_add_u32 s70, s100, s70
    s_and_b32 s62, s101, 1
    s_lshl3_add_u32 s70, s62, s70
    s_lshr_b32 s62, s101, 1
    s_lshl1_add_u32 s70, s70, s62
    s_sub_u32 s60, s56, 1
    s_lshl1_add_u32 s63, s70, s60
    s_lshl_b32 s62, s71, 8
    s_add_u32 s63, s63, s62
    s_lshl_b32 s63, s63, 10
    v_lshrrev_b32 v1, 4, v255
    v_and_b32 v2, 15, v255
    v_lshlrev_b32 v3, 4, v2
    v_lshl_add_u32 v3, v1, 16, v3
    s_waitcnt lgkmcnt(0)
    s_mov_b64 s[8:9], s[32:33]
    v_mov_b32 v128, 9535488
    global_load_dword v128, v128, s[54:55] sc1
    buffer_load_dwordx4 v[168:171], v3, s[8:11], s63 offen offset:0
    buffer_load_dwordx4 v[172:175], v3, s[8:11], s63 offen offset:256
    buffer_load_dwordx4 v[176:179], v3, s[8:11], s63 offen offset:512
    buffer_load_dwordx4 v[180:183], v3, s[8:11], s63 offen offset:768
    s_branch L_r1b_12
L_ld_2:
    s_sub_u32 s74, s56, 4
    s_lshl_b32 s92, s74, 10
    v_lshrrev_b32 v1, 3, v255
    v_lshl_add_u32 v1, s74, 3, v1
    v_bfe_u32 v2, v1, 1, 3
    v_and_b32 v3, 7, v255
    v_xor_b32 v2, v2, v3
    v_lshlrev_b32 v2, 4, v2
    s_mov_b32 s14, 1835008
    s_mov_b32 s15, s11
    s_mov_b32 s18, s14
    s_mov_b32 s19, s11
    s_cmp_ge_u32 s58, 14
    s_cbranch_scc1 L_lsp_13
    v_lshl_add_u32 v10, v1, 15, v2
    v_lshrrev_b32 v3, 4, v255
    v_lshl_add_u32 v4, s74, 2, v3
    v_mul_u32_u24 v4, 3584, v4
    s_lshr_b32 s62, s74, 1
    v_lshl_or_b32 v3, s62, 2, v3
    v_lshlrev_b32 v3, 1, v3
    v_and_b32 v5, 15, v255
    v_xor_b32 v3, v3, v5
    v_lshl_add_u32 v11, v3, 4, v4
    s_and_b32 s64, s58, 1
    s_lshl1_add_u32 s64, s57, s64
    s_lshl_b32 s64, s64, 10
    s_add_u32 s65, s64, 0x100000
    s_xor_b32 s66, s64, 0x400
    s_xor_b32 s67, s65, 0x400
    s_lshl_b32 s68, s58, 8
    s_mov_b32 s62, 57344
    s_mov_b32 s72, 229376
    s_add_u32 s69, s68, s62
    s_add_u32 s70, s69, s62
    s_add_u32 s71, s70, s62
    s_branch L_ljn_14
L_lsp_13:
    s_and_b32 s62, s74, 1
    s_lshr_b32 s63, s74, 1
    s_lshl2_add_u32 s62, s63, s62
    s_lshl_b32 s62, s62, 1
    v_xor_b32 v10, s62, v255
    v_lshlrev_b32 v10, 4, v10
    v_mov_b32 v11, v10
    s_sub_u32 s62, s58, 14
    s_lshl1_add_u32 s62, s57, s62
    s_lshl_b32 s64, s74, 5
    s_add_u32 s64, s64, s62
    s_lshl_b32 s64, s64, 11
L_ljn_14:
    s_waitcnt lgkmcnt(0)
    s_mov_b64 s[8:9], s[32:33]
    s_mov_b64 s[12:13], s[44:45]
    s_mov_b64 s[16:17], s[46:47]
    v_mov_b32 v9, 9535488
    global_load_dword v9, v9, s[54:55] sc1
    s_cmp_ge_u32 s58, 14
    s_cbranch_scc1 L_fs_15
    s_add_u32 m0, s92, 0
    s_nop 0
    buffer_load_dwordx4 v10, s[8:11], s64 offen  lds
    s_addk_i32 m0, 16384
    s_addk_i32 s64, 128
    buffer_load_dwordx4 v11, s[12:15], s68 offen  lds
    s_addk_i32 m0, 16384
    s_nop 0
    buffer_load_dwordx4 v11, s[16:19], s68 offen  lds
    s_branch L_fj_16
L_fs_15:
    s_add_u32 m0, s92, 0
    s_add_u32 s62, s64, 0
    buffer_load_dwordx4 v10, s[8:11], s62 offen  lds
    s_addk_i32 m0, 4096
    s_add_u32 s62, s64, 262144
    buffer_load_dwordx4 v10, s[8:11], s62 offen  lds
    s_addk_i32 m0, 4096
    s_add_u32 s62, s64, 524288
    buffer_load_dwordx4 v10, s[8:11], s62 offen  lds
    s_addk_i32 m0, 4096
    s_add_u32 s62, s64, 786432
    buffer_load_dwordx4 v10, s[8:11], s62 offen  lds
    s_addk_i32 m0, 4096
    s_add_u32 s62, s64, 1048576
    buffer_load_dwordx4 v10, s[8:11], s62 offen  lds
    s_addk_i32 m0, 4096
    s_add_u32 s62, s64, 1310720
    buffer_load_dwordx4 v10, s[8:11], s62 offen  lds
    s_addk_i32 m0, 4096
    s_add_u32 s62, s64, 1572864
    buffer_load_dwordx4 v10, s[8:11], s62 offen  lds
    s_addk_i32 m0, 4096
    s_add_u32 s62, s64, 1835008
    buffer_load_dwordx4 v10, s[8:11], s62 offen  lds
L_fj_16:
    s_and_b32 s60, s2, 7
    s_bfe_u32 s62, s93, 0x10001
    s_lshl1_add_u32 s59, s60, s62
    s_sub_u32 s62, 32, s59
    s_cmp_eq_u32 s59, 0
    s_cselect_b32 s62, 16, s62
    s_bitcmp1_b32 s93, 0
    s_cselect_b32 s59, s62, s59
    s_lshr_b32 s3, s93, 2
    s_xor_b32 s3, s3, 4
    v_and_b32 v12, 15, v255
    v_lshrrev_b32 v13, 4, v255
    s_mov_b32 s63, 0x3a000000
    s_mov_b32 s60, 0x8000
    s_mov_b32 s61, 0x80000000
    s_cmp_ge_u32 s3, 4
    s_cselect_b32 s90, 0xba000000, s63
    s_cselect_b32 s75, s61, s60
    s_cselect_b32 s73, s60, s61
    s_mov_b64 s[20:21], s[54:55]
    s_mov_b32 s22, 13107200
    s_mov_b32 s23, 0x00020000
    s_mov_b64 s[24:25], s[48:49]
    s_mov_b32 s26, 1835008
    s_mov_b32 s27, 0x00020000
    v_and_b32 v6, 7, v255
    v_lshlrev_b32 v5, 1, v13
    v_xor_b32 v6, v6, v5
    v_lshlrev_b32 v6, 4, v6
    v_lshl_add_u32 v6, v1, 10, v6
    s_and_b32 s60, s59, 1
    s_lshl_b32 s60, s60, 10
    s_add_u32 s60, s60, s3
    v_lshl_add_u32 v18, s60, 7, v6
    v_xor_b32 v17, 0x20000, v18
    s_mov_b32 s80, 0
    s_mov_b32 s81, 262144
    s_mov_b32 s82, 524288
    s_mov_b32 s83, 786432
    s_mov_b32 s84, 1048576
    s_mov_b32 s85, 1310720
    s_mov_b32 s86, 1572864
    s_lshl2_add_u32 s60, s2, s74
    s_mul_i32 s60, s60, 448
    s_add_u32 s60, s60, 917504
    s_add_u32 s76, s48, s60
    s_addc_u32 s77, s49, 0
    s_lshl4_add_u32 s61, s57, s58
    s_lshl_b32 s61, s61, 9
    s_add_u32 s61, s61, 10223616
    s_add_u32 s42, s54, s61
    s_addc_u32 s43, s55, 0
    v_and_b32 v5, 1, v255
    v_lshlrev_b32 v5, 8, v5
    buffer_load_dwordx2 v[32:33], v5, s[20:23], s61 offen sc1
    s_cmp_ge_u32 s58, 14
    s_cbranch_scc1 L_lspec_17
    s_addk_i32 m0, -28672
    s_add_u32 s68, s68, s72
    buffer_load_dwordx4 v10, s[8:11], s65 offen  lds
    s_addk_i32 m0, 16384
    s_addk_i32 s65, 128
    buffer_load_dwordx4 v11, s[12:15], s69 offen  lds
    s_addk_i32 m0, 16384
    s_nop 0
    buffer_load_dwordx4 v11, s[16:19], s69 offen  lds
    s_addk_i32 m0, -28672
    s_add_u32 s69, s69, s72
    buffer_load_dwordx4 v10, s[8:11], s66 offen  lds
    s_addk_i32 m0, 16384
    s_addk_i32 s66, 128
    buffer_load_dwordx4 v11, s[12:15], s70 offen  lds
    s_addk_i32 m0, 16384
    s_nop 0
    buffer_load_dwordx4 v11, s[16:19], s70 offen  lds
    s_addk_i32 m0, -28672
    s_add_u32 s70, s70, s72
    buffer_load_dwordx4 v10, s[8:11], s67 offen  lds
    s_addk_i32 m0, 16384
    s_addk_i32 s67, 128
    buffer_load_dwordx4 v11, s[12:15], s71 offen  lds
    s_addk_i32 m0, 16384
    s_nop 0
    buffer_load_dwordx4 v11, s[16:19], s71 offen  lds
    s_addk_i32 m0, 4096
    s_add_u32 s71, s71, s72
    buffer_load_dwordx4 v10, s[8:11], s64 offen  lds
    s_addk_i32 m0, 16384
    s_addk_i32 s64, 128
    buffer_load_dwordx4 v11, s[12:15], s68 offen  lds
    s_addk_i32 m0, 16384
    s_nop 0
    buffer_load_dwordx4 v11, s[16:19], s68 offen  lds
    s_addk_i32 m0, -28672
    s_add_u32 s68, s68, s72
    buffer_load_dwordx4 v10, s[8:11], s65 offen  lds
    s_addk_i32 m0, 16384
    s_addk_i32 s65, 128
    buffer_load_dwordx4 v11, s[12:15], s69 offen  lds
    s_addk_i32 m0, 16384
    s_nop 0
    buffer_load_dwordx4 v11, s[16:19], s69 offen  lds
    s_addk_i32 m0, -28672
    s_add_u32 s69, s69, s72
    buffer_load_dwordx4 v10, s[8:11], s66 offen  lds
    s_addk_i32 m0, 16384
    s_addk_i32 s66, 128
    buffer_load_dwordx4 v11, s[12:15], s70 offen  lds
    s_addk_i32 m0, 16384
    s_nop 0
    buffer_load_dwordx4 v11, s[16:19], s70 offen  lds
    s_addk_i32 m0, -28672
    s_add_u32 s70, s70, s72
    buffer_load_dwordx4 v10, s[8:11], s67 offen  lds
    s_addk_i32 m0, 16384
    s_addk_i32 s67, 128
    buffer_load_dwordx4 v11, s[12:15], s71 offen  lds
    s_addk_i32 m0, 16384
    s_nop 0
    buffer_load_dwordx4 v11, s[16:19], s71 offen  lds
    s_load_dword s95, s[76:77], -458752
    s_load_dword s95, s[76:77], -458688
    s_load_dword s95, s[76:77], -458624
    s_load_dword s95, s[76:77], -458560
    s_load_dword s95, s[76:77], -458496
    s_load_dword s95, s[76:77], -458432
    s_load_dword s95, s[76:77], -458368
    s_load_dword s95, s[76:77], 0
    s_load_dword s95, s[76:77], 64
    s_load_dword s95, s[76:77], 128
    s_load_dword s95, s[76:77], 192
    s_load_dword s95, s[76:77], 256
    s_load_dword s95, s[76:77], 320
    s_load_dword s95, s[76:77], 384
    s_waitcnt vmcnt(12)
    s_barrier
    s_addk_i32 m0, 4096
    s_add_u32 s71, s71, s72
    buffer_load_dwordx4 v10, s[8:11], s64 offen  lds
    v_lshrrev_b32 v5, 3, v255
    v_xor_b32 v6, v5, v255
    v_and_b32 v6, 7, v6
    s_addk_i32 m0, 16384
    s_addk_i32 s64, 128
    buffer_load_dwordx4 v11, s[12:15], s68 offen  lds
    v_lshlrev_b32 v6, 4, v6
    v_lshl_add_u32 v35, v5, 15, v6
    s_lshl_b32 s5, s74, 9
    s_add_u32 s5, s5, s59
    s_lshl3_add_u32 s5, s5, s3
    s_lshl_b32 s5, s5, 7
    s_addk_i32 m0, 16384
    s_nop 0
    buffer_load_dwordx4 v11, s[16:19], s68 offen  lds
    v_and_b32 v5, 31, v255
    v_and_b32 v3, 1, v5
    v_lshlrev_b32 v3, 10, v3
    s_addk_i32 m0, -28672
    s_add_u32 s68, s68, s72
    buffer_load_dwordx4 v10, s[8:11], s65 offen  lds
    v_and_b32 v4, 30, v5
    s_and_b32 s60, s74, 1
    s_lshr_b32 s63, s74, 1
    s_and_b32 s61, s58, 1
    s_xor_b32 s63, s63, s61
    s_lshl1_add_u32 s61, s57, s60
    s_lshl_b32 s61, s61, 5
    s_add_u32 s61, s61, s63
    s_addk_i32 m0, 16384
    s_addk_i32 s65, 128
    buffer_load_dwordx4 v11, s[12:15], s69 offen  lds
    v_add3_u32 v20, v3, v4, s61
    v_lshlrev_b32 v5, 4, v5
    v_lshrrev_b32 v6, 5, v255
    s_addk_i32 m0, 16384
    s_nop 0
    buffer_load_dwordx4 v11, s[16:19], s69 offen  lds
    v_mul_u32_u24 v6, 7168, v6
    s_lshl_b32 s61, s58, 9
    s_mul_i32 s88, s74, 14336
    s_add_u32 s88, s88, 9469952
    v_add3_u32 v22, v5, v6, s61
    s_addk_i32 m0, -28672
    s_add_u32 s69, s69, s72
    buffer_load_dwordx4 v10, s[8:11], s66 offen  lds
    v_mov_b32 v15, 0x0c0c0400
    v_mov_b32 v16, 0x04000c0c
    v_lshlrev_b32 v20, 4, v20
    s_mov_b32 s87, 9437184
    s_addk_i32 m0, 16384
    s_addk_i32 s66, 128
    buffer_load_dwordx4 v11, s[12:15], s70 offen  lds
    v_lshl_add_u32 v21, v255, 4, s92
    v_add_u32 v23, 0x10000, v21
    v_add_u32 v34, 0x20000, v21
    s_addk_i32 m0, 16384
    s_nop 0
    buffer_load_dwordx4 v11, s[16:19], s70 offen  lds
    s_lshl2_add_u32 s60, s3, s74
    s_lshl_b32 s60, s60, 4
    s_sub_u32 s61, 32, s59
    s_and_b32 s61, s61, 31
    v_add_u32 v3, s60, v12
    v_sub_u32 v4, 512, v3
    s_load_dword s95, s[76:77], 458752
    s_load_dword s95, s[76:77], 458816
    s_load_dword s95, s[76:77], 458880
    s_load_dword s95, s[76:77], 458944
    s_load_dword s95, s[76:77], 459008
    s_load_dword s95, s[76:77], 459072
    s_load_dword s95, s[76:77], 459136
    s_add_u32 s62, s82, 32768
    buffer_load_dwordx4 v[128:131], v17, s[24:27], s62 offen
    s_add_u32 s62, s82, 98304
    buffer_load_dwordx4 v[132:135], v17, s[24:27], s62 offen
    s_add_u32 s62, s83, 0
    buffer_load_dwordx4 v[136:139], v17, s[24:27], s62 offen
    s_add_u32 s62, s83, 65536
    buffer_load_dwordx4 v[140:143], v17, s[24:27], s62 offen
    s_add_u32 s62, s83, 32768
    buffer_load_dwordx4 v[144:147], v17, s[24:27], s62 offen
    s_add_u32 s62, s83, 98304
    buffer_load_dwordx4 v[148:151], v17, s[24:27], s62 offen
    v_readfirstlane_b32 s6, v9
    s_nop 0
    s_mul_i32 s6, s6, 0x9e3779b1
    s_add_u32 s6, s6, 0x7f4a7c15
    s_not_b32 s7, s6
    s_waitcnt vmcnt(15)
    s_barrier
    s_addk_i32 m0, -28672
    s_add_u32 s70, s70, s72
    buffer_load_dwordx4 v10, s[8:11], s67 offen  lds
    v_readlane_b32 s44, v32, 0
    s_addk_i32 m0, 16384
    s_addk_i32 s67, 128
    buffer_load_dwordx4 v11, s[12:15], s71 offen  lds
    v_readlane_b32 s45, v33, 0
    s_addk_i32 m0, 16384
    s_nop 0
    buffer_load_dwordx4 v11, s[16:19], s71 offen  lds
    v_readlane_b32 s46, v32, 1
    s_add_u32 m0, s92, 0
    s_add_u32 s71, s71, s72
    buffer_load_dwordx4 v10, s[8:11], s64 offen  lds
    v_readlane_b32 s47, v33, 1
    s_addk_i32 m0, 16384
    s_addk_i32 s64, 128
    buffer_load_dwordx4 v11, s[12:15], s68 offen  lds
    s_nop 0
    s_addk_i32 m0, 16384
    s_nop 0
    buffer_load_dwordx4 v11, s[16:19], s68 offen  lds
    s_sub_u32 s44, s6, s44
    s_subb_u32 s45, s7, s45
    s_sub_u32 s46, s6, s46
    s_subb_u32 s47, s7, s47
    s_addk_i32 m0, -28672
    s_add_u32 s68, s68, s72
    buffer_load_dwordx4 v10, s[8:11], s65 offen  lds
    s_cmp_ge_u32 s3, 4
    s_cselect_b32 s61, s61, s59
    s_cselect_b64 vcc, -1, 0
    s_mul_i32 s61, s61, 69632
    s_add_u32 s91, s61, 10485760
    v_cndmask_b32 v4, v3, v4, vcc
    v_and_b32 v5, 64, v4
    s_addk_i32 m0, 16384
    s_addk_i32 s65, 128
    buffer_load_dwordx4 v11, s[12:15], s69 offen  lds
    v_cmp_ne_u32 vcc, 0, v5
    v_sub_u32 v5, 0, v4
    v_and_b32 v6, 0xc0, v4
    s_addk_i32 m0, 16384
    s_nop 0
    buffer_load_dwordx4 v11, s[16:19], s69 offen  lds
    v_cndmask_b32 v4, v4, v5, vcc
    v_and_or_b32 v4, v4, 63, v6
    v_and_b32 v5, 15, v4
    s_addk_i32 m0, -28672
    s_add_u32 s69, s69, s72
    buffer_load_dwordx4 v10, s[8:11], s66 offen  lds
    v_lshrrev_b32 v4, 4, v4
    v_lshl_add_u32 v4, v4, 4, v13
    v_lshl_add_u32 v4, v4, 5, v5
    s_addk_i32 m0, 16384
    s_addk_i32 s66, 128
    buffer_load_dwordx4 v11, s[12:15], s70 offen  lds
    v_cmp_eq_u32 vcc, 0, v3
    v_lshlrev_b32 v4, 3, v4
    v_add_u32 v5, 0x10000, v4
    s_addk_i32 m0, 16384
    s_nop 0
    buffer_load_dwordx4 v11, s[16:19], s70 offen  lds
    v_cndmask_b32 v19, v4, v5, vcc
    v_mov_b32 v8, 0
    s_lshr_b32 s61, s59, 1
    s_and_b32 s63, s59, 1
    s_lshl4_add_u32 s61, s61, s63
    s_lshl_b32 s61, s61, 9
    s_add_u32 s61, s61, 10223616
    s_addk_i32 m0, -28672
    s_add_u32 s70, s70, s72
    buffer_load_dwordx4 v10, s[8:11], s67 offen  lds
    s_xor_b32 s63, s61, 0x300
    s_add_u32 s34, s54, s61
    s_addc_u32 s35, s55, 0
    s_add_u32 s36, s54, s63
    s_addc_u32 s37, s55, 0
    v_lshlrev_b32 v60, 2, v13
    v_cvt_f32_u32 v60, v60
    s_addk_i32 m0, 16384
    s_addk_i32 s67, 128
    buffer_load_dwordx4 v11, s[12:15], s71 offen  lds
    v_lshl_add_u32 v61, v12, 5, s59
    v_cvt_f32_u32 v61, v61
    v_mul_f32 v61, s90, v61
    s_addk_i32 m0, 16384
    s_nop 0
    buffer_load_dwordx4 v11, s[16:19], s71 offen  lds
    v_add_f32 v40, 0x0, v60
    v_mul_f32 v40, v40, v61
    v_add_f32 v41, v40, v61
    s_add_u32 s62, s84, 0
    buffer_load_dwordx4 v[152:155], v17, s[24:27], s62 offen
    s_add_u32 s62, s84, 65536
    buffer_load_dwordx4 v[156:159], v17, s[24:27], s62 offen
    s_add_u32 s62, s84, 32768
    buffer_load_dwordx4 v[160:163], v17, s[24:27], s62 offen
    s_add_u32 s62, s84, 98304
    buffer_load_dwordx4 v[164:167], v17, s[24:27], s62 offen
    s_add_u32 s62, s85, 0
    buffer_load_dwordx4 v[168:171], v17, s[24:27], s62 offen
    s_add_u32 s62, s85, 65536
    buffer_load_dwordx4 v[172:175], v17, s[24:27], s62 offen
    s_waitcnt vmcnt(18)
    s_barrier
    s_addk_i32 m0, 4096
    s_add_u32 s71, s71, s72
    buffer_load_dwordx4 v10, s[8:11], s64 offen  lds
    v_add_f32 v42, v41, v61
    v_add_f32 v43, v42, v61
    v_cos_f32 v44, v40
    s_addk_i32 m0, 16384
    s_addk_i32 s64, 128
    buffer_load_dwordx4 v11, s[12:15], s68 offen  lds
    v_sin_f32 v48, v40
    v_cos_f32 v45, v41
    v_sin_f32 v49, v41
    s_addk_i32 m0, 16384
    s_nop 0
    buffer_load_dwordx4 v11, s[16:19], s68 offen  lds
    v_cos_f32 v46, v42
    v_sin_f32 v50, v42
    v_cos_f32 v47, v43
    s_addk_i32 m0, -28672
    s_add_u32 s68, s68, s72
    buffer_load_dwordx4 v10, s[8:11], s65 offen  lds
    v_sin_f32 v51, v43
    v_cvt_pk_bf16_f32 v64, v44, v48
    v_cvt_pk_bf16_f32 v65, v45, v49
    s_addk_i32 m0, 16384
    s_addk_i32 s65, 128
    buffer_load_dwordx4 v11, s[12:15], s69 offen  lds
    v_cvt_pk_bf16_f32 v66, v46, v50
    v_cvt_pk_bf16_f32 v67, v47, v51
    v_cvt_pk_bf16_f32 v40, v49, v45
    s_addk_i32 m0, 16384
    s_nop 0
    buffer_load_dwordx4 v11, s[16:19], s69 offen  lds
    v_cvt_pk_bf16_f32 v41, v51, v47
    v_mov_b32 v80, v64
    v_mov_b32 v96, v64
    s_addk_i32 m0, -28672
    s_add_u32 s69, s69, s72
    buffer_load_dwordx4 v10, s[8:11], s66 offen  lds
    v_mov_b32 v112, v64
    v_xor_b32 v81, s75, v40
    v_xor_b32 v113, s73, v40
    s_addk_i32 m0, 16384
    s_addk_i32 s66, 128
    buffer_load_dwordx4 v11, s[12:15], s70 offen  lds
    v_xor_b32 v83, s73, v41
    v_xor_b32 v115, s75, v41
    v_xor_b32 v97, 0x80008000, v65
    s_addk_i32 m0, 16384
    s_nop 0
    buffer_load_dwordx4 v11, s[16:19], s70 offen  lds
    v_xor_b32 v99, 0x80008000, v67
    v_xor_b32 v82, 0x80008000, v66
    v_mov_b32 v98, v66
    s_addk_i32 m0, -28672
    s_add_u32 s70, s70, s72
    buffer_load_dwordx4 v10, s[8:11], s67 offen  lds
    v_mov_b32 v114, v82
    v_add_f32 v40, 0x41800000, v60
    v_mul_f32 v40, v40, v61
    s_addk_i32 m0, 16384
    s_addk_i32 s67, 128
    buffer_load_dwordx4 v11, s[12:15], s71 offen  lds
    v_add_f32 v41, v40, v61
    v_add_f32 v42, v41, v61
    v_add_f32 v43, v42, v61
    s_addk_i32 m0, 16384
    s_nop 0
    buffer_load_dwordx4 v11, s[16:19], s71 offen  lds
    v_cos_f32 v44, v40
    v_sin_f32 v48, v40
    v_cos_f32 v45, v41
    s_load_dword s95, s[76:77], -917504
    s_load_dword s95, s[76:77], -917440
    s_load_dword s95, s[76:77], -917376
    s_load_dword s95, s[76:77], -917312
    s_load_dword s95, s[76:77], -917248
    s_load_dword s95, s[76:77], -917184
    s_load_dword s95, s[76:77], -917120
    buffer_load_dwordx4 v[52:55], v35, s[8:11], s5 offen
    s_add_u32 s5, s5, 0x40000
    buffer_load_dwordx4 v[56:59], v35, s[8:11], s5 offen
    s_waitcnt vmcnt(20)
    s_barrier
    buffer_load_dwordx4 v[24:27], v20, s[20:23], s87 offen sc1
    buffer_load_dwordx4 v[28:31], v22, s[20:23], s88 offen sc1
    s_addk_i32 m0, 4096
    s_add_u32 s71, s71, s72
    buffer_load_dwordx4 v10, s[8:11], s64 offen  lds
    v_sin_f32 v49, v41
    v_cos_f32 v46, v42
    v_sin_f32 v50, v42
    s_addk_i32 m0, 16384
    s_addk_i32 s64, 128
    buffer_load_dwordx4 v11, s[12:15], s68 offen  lds
    v_cos_f32 v47, v43
    v_sin_f32 v51, v43
    v_cvt_pk_bf16_f32 v68, v44, v48
    s_addk_i32 m0, 16384
    s_nop 0
    buffer_load_dwordx4 v11, s[16:19], s68 offen  lds
    v_cvt_pk_bf16_f32 v69, v45, v49
    v_cvt_pk_bf16_f32 v70, v46, v50
    v_cvt_pk_bf16_f32 v71, v47, v51
    s_addk_i32 m0, -28672
    s_add_u32 s68, s68, s72
    buffer_load_dwordx4 v10, s[8:11], s65 offen  lds
    v_cvt_pk_bf16_f32 v40, v49, v45
    v_cvt_pk_bf16_f32 v41, v51, v47
    v_mov_b32 v84, v68
    s_addk_i32 m0, 16384
    s_addk_i32 s65, 128
    buffer_load_dwordx4 v11, s[12:15], s69 offen  lds
    v_mov_b32 v100, v68
    v_mov_b32 v116, v68
    v_xor_b32 v85, s75, v40
    s_addk_i32 m0, 16384
    s_nop 0
    buffer_load_dwordx4 v11, s[16:19], s69 offen  lds
    v_xor_b32 v117, s73, v40
    v_xor_b32 v87, s73, v41
    v_xor_b32 v119, s75, v41
    s_addk_i32 m0, -28672
    s_add_u32 s69, s69, s72
    buffer_load_dwordx4 v10, s[8:11], s66 offen  lds
    v_xor_b32 v101, 0x80008000, v69
    v_xor_b32 v103, 0x80008000, v71
    v_xor_b32 v86, 0x80008000, v70
    s_addk_i32 m0, 16384
    s_addk_i32 s66, 128
    buffer_load_dwordx4 v11, s[12:15], s70 offen  lds
    v_mov_b32 v102, v70
    v_mov_b32 v118, v86
    v_add_f32 v40, 0x42000000, v60
    s_addk_i32 m0, 16384
    s_nop 0
    buffer_load_dwordx4 v11, s[16:19], s70 offen  lds
    v_mul_f32 v40, v40, v61
    v_add_f32 v41, v40, v61
    v_add_f32 v42, v41, v61
    s_addk_i32 m0, -28672
    s_add_u32 s70, s70, s72
    buffer_load_dwordx4 v10, s[8:11], s67 offen  lds
    v_add_f32 v43, v42, v61
    v_cos_f32 v44, v40
    v_sin_f32 v48, v40
    s_addk_i32 m0, 16384
    s_addk_i32 s67, 128
    buffer_load_dwordx4 v11, s[12:15], s71 offen  lds
    v_cos_f32 v45, v41
    v_sin_f32 v49, v41
    v_cos_f32 v46, v42
    s_addk_i32 m0, 16384
    s_nop 0
    buffer_load_dwordx4 v11, s[16:19], s71 offen  lds
    v_sin_f32 v50, v42
    v_cos_f32 v47, v43
    v_sin_f32 v51, v43
    s_waitcnt vmcnt(12)
    s_barrier
    s_add_u32 m0, s92, 0
    s_add_u32 s71, s71, s72
    buffer_load_dwordx4 v10, s[8:11], s64 offen  lds
    v_perm_b32 v3, v29, v28, v15
    s_addk_i32 m0, 16384
    s_addk_i32 s64, 128
    buffer_load_dwordx4 v11, s[12:15], s68 offen  lds
    v_perm_b32 v4, v31, v30, v16
    s_addk_i32 m0, 16384
    s_nop 0
    buffer_load_dwordx4 v11, s[16:19], s68 offen  lds
    v_xor_b32 v5, s6, v25
    s_addk_i32 m0, -28672
    s_add_u32 s68, s68, s72
    buffer_load_dwordx4 v10, s[8:11], s65 offen  lds
    v_or_b32 v3, v3, v4
    s_addk_i32 m0, 16384
    s_addk_i32 s65, 128
    buffer_load_dwordx4 v11, s[12:15], s69 offen  lds
    v_xor_b32 v3, s6, v3
    s_addk_i32 m0, 16384
    s_nop 0
    buffer_load_dwordx4 v11, s[16:19], s69 offen  lds
    v_or_b32 v3, v3, v5
    v_cmp_ne_u32 vcc, 0, v3
    s_cbranch_vccz L_ok_20
    s_mov_b32 s89, 100000
L_rt_19:
    buffer_load_dwordx4 v[24:27], v20, s[20:23], s87 offen sc1
    buffer_load_dwordx4 v[28:31], v22, s[20:23], s88 offen sc1
    s_waitcnt vmcnt(0)
    v_perm_b32 v3, v29, v28, v15
    v_perm_b32 v4, v31, v30, v16
    v_xor_b32 v5, s6, v25
    v_or_b32 v3, v3, v4
    v_xor_b32 v3, s6, v3
    v_or_b32 v3, v3, v5
    v_cmp_ne_u32 vcc, 0, v3
    s_cbranch_vccz L_ok_20
    s_sleep 2
    s_sub_u32 s89, s89, 1
    s_cmp_lg_u32 s89, 0
    s_cbranch_scc1 L_rt_19
L_ok_20:
    s_addk_i32 m0, -28672
    s_add_u32 s69, s69, s72
    buffer_load_dwordx4 v10, s[8:11], s66 offen  lds
    v_cvt_pk_bf16_f32 v72, v44, v48
    v_cvt_pk_bf16_f32 v73, v45, v49
    v_cvt_pk_bf16_f32 v74, v46, v50
    s_addk_i32 m0, 16384
    s_addk_i32 s66, 128
    buffer_load_dwordx4 v11, s[12:15], s70 offen  lds
    v_cvt_pk_bf16_f32 v75, v47, v51
    v_cvt_pk_bf16_f32 v40, v49, v45
    v_cvt_pk_bf16_f32 v41, v51, v47
    s_addk_i32 m0, 16384
    s_nop 0
    buffer_load_dwordx4 v11, s[16:19], s70 offen  lds
    v_mov_b32 v88, v72
    v_mov_b32 v104, v72
    v_mov_b32 v120, v72
    s_addk_i32 m0, -28672
    s_add_u32 s70, s70, s72
    buffer_load_dwordx4 v10, s[8:11], s67 offen  lds
    v_xor_b32 v89, s75, v40
    v_xor_b32 v121, s73, v40
    v_xor_b32 v91, s73, v41
    s_addk_i32 m0, 16384
    s_addk_i32 s67, 128
    buffer_load_dwordx4 v11, s[12:15], s71 offen  lds
    v_xor_b32 v123, s75, v41
    v_xor_b32 v105, 0x80008000, v73
    v_xor_b32 v107, 0x80008000, v75
    s_addk_i32 m0, 16384
    s_nop 0
    buffer_load_dwordx4 v11, s[16:19], s71 offen  lds
    v_xor_b32 v90, 0x80008000, v74
    v_mov_b32 v106, v74
    v_mov_b32 v122, v90
    s_waitcnt vmcnt(12)
    s_barrier
    s_addk_i32 m0, 4096
    s_add_u32 s71, s71, s72
    buffer_load_dwordx4 v10, s[8:11], s64 offen  lds
    v_add_f32 v40, 0x42400000, v60
    v_mul_f32 v40, v40, v61
    v_add_f32 v41, v40, v61
    s_addk_i32 m0, 16384
    s_addk_i32 s64, 128
    buffer_load_dwordx4 v11, s[12:15], s68 offen  lds
    v_add_f32 v42, v41, v61
    v_add_f32 v43, v42, v61
    v_cos_f32 v44, v40
    s_addk_i32 m0, 16384
    s_nop 0
    buffer_load_dwordx4 v11, s[16:19], s68 offen  lds
    v_sin_f32 v48, v40
    v_cos_f32 v45, v41
    v_sin_f32 v49, v41
    s_addk_i32 m0, -28672
    s_add_u32 s68, s68, s72
    buffer_load_dwordx4 v10, s[8:11], s65 offen  lds
    v_cos_f32 v46, v42
    v_sin_f32 v50, v42
    v_cos_f32 v47, v43
    s_addk_i32 m0, 16384
    s_addk_i32 s65, 128
    buffer_load_dwordx4 v11, s[12:15], s69 offen  lds
    v_sin_f32 v51, v43
    v_cvt_pk_bf16_f32 v76, v44, v48
    v_cvt_pk_bf16_f32 v77, v45, v49
    s_addk_i32 m0, 16384
    s_nop 0
    buffer_load_dwordx4 v11, s[16:19], s69 offen  lds
    v_cvt_pk_bf16_f32 v78, v46, v50
    v_cvt_pk_bf16_f32 v79, v47, v51
    v_cvt_pk_bf16_f32 v40, v49, v45
    s_addk_i32 m0, -28672
    s_add_u32 s69, s69, s72
    buffer_load_dwordx4 v10, s[8:11], s66 offen  lds
    v_cvt_pk_bf16_f32 v41, v51, v47
    v_mov_b32 v92, v76
    v_mov_b32 v108, v76
    s_addk_i32 m0, 16384
    s_addk_i32 s66, 128
    buffer_load_dwordx4 v11, s[12:15], s70 offen  lds
    v_mov_b32 v124, v76
    v_xor_b32 v93, s75, v40
    v_xor_b32 v125, s73, v40
    s_addk_i32 m0, 16384
    s_nop 0
    buffer_load_dwordx4 v11, s[16:19], s70 offen  lds
    v_xor_b32 v95, s73, v41
    v_xor_b32 v127, s75, v41
    v_xor_b32 v109, 0x80008000, v77
    s_addk_i32 m0, -28672
    s_add_u32 s70, s70, s72
    buffer_load_dwordx4 v10, s[8:11], s67 offen  lds
    v_xor_b32 v111, 0x80008000, v79
    v_xor_b32 v94, 0x80008000, v78
    v_mov_b32 v110, v78
    s_addk_i32 m0, 16384
    s_addk_i32 s67, 128
    buffer_load_dwordx4 v11, s[12:15], s71 offen  lds
    v_mov_b32 v126, v94
    s_addk_i32 m0, 16384
    s_nop 0
    buffer_load_dwordx4 v11, s[16:19], s71 offen  lds
    s_waitcnt vmcnt(12)
    s_barrier
    s_add_u32 m0, s92, 158208
    s_lshr_b32 s61, s92, 1
    buffer_load_dwordx4 v22, s[20:23], s88 offen sc1 lds
    s_add_u32 m0, s61, 155648
    s_mov_b32 exec_hi, 0
    buffer_load_dwordx4 v20, s[20:23], s87 offen sc1 lds
    s_mov_b32 exec_hi, -1
    s_add_u32 m0, s92, 98304
    s_add_u32 s62, s80, 0
    buffer_load_dwordx4 v18, s[24:27], s62 offen  lds
    s_addk_i32 m0, 4096
    s_add_u32 s62, s80, 65536
    buffer_load_dwordx4 v18, s[24:27], s62 offen  lds
    s_addk_i32 m0, 4096
    s_add_u32 s62, s80, 32768
    buffer_load_dwordx4 v18, s[24:27], s62 offen  lds
    s_addk_i32 m0, 4096
    s_add_u32 s62, s80, 98304
    buffer_load_dwordx4 v18, s[24:27], s62 offen  lds
    s_addk_i32 m0, 4096
    s_add_u32 s62, s81, 0
    buffer_load_dwordx4 v18, s[24:27], s62 offen  lds
    s_addk_i32 m0, 4096
    s_add_u32 s62, s81, 65536
    buffer_load_dwordx4 v18, s[24:27], s62 offen  lds
    s_addk_i32 m0, 4096
    s_add_u32 s62, s81, 32768
    buffer_load_dwordx4 v18, s[24:27], s62 offen  lds
    s_addk_i32 m0, 4096
    s_add_u32 s62, s81, 98304
    buffer_load_dwordx4 v18, s[24:27], s62 offen  lds
    s_waitcnt vmcnt(8)
    s_barrier
    s_addk_i32 m0, 4096
    s_add_u32 s62, s82, 0
    buffer_load_dwordx4 v18, s[24:27], s62 offen  lds
    s_addk_i32 m0, 4096
    s_add_u32 s62, s82, 65536
    buffer_load_dwordx4 v18, s[24:27], s62 offen  lds
    s_addk_i32 m0, 4096
    s_add_u32 s62, s82, 32768
    buffer_load_dwordx4 v18, s[24:27], s62 offen  lds
    s_addk_i32 m0, 4096
    s_add_u32 s62, s82, 98304
    buffer_load_dwordx4 v18, s[24:27], s62 offen  lds
    s_addk_i32 m0, 4096
    s_add_u32 s62, s83, 0
    buffer_load_dwordx4 v18, s[24:27], s62 offen  lds
    s_addk_i32 m0, 4096
    s_add_u32 s62, s83, 65536
    buffer_load_dwordx4 v18, s[24:27], s62 offen  lds
    s_add_u32 s62, s85, 32768
    buffer_load_dwordx4 v[176:179], v17, s[24:27], s62 offen
    s_add_u32 s62, s85, 98304
    buffer_load_dwordx4 v[180:183], v17, s[24:27], s62 offen
    s_add_u32 s62, s86, 0
    buffer_load_dwordx4 v[184:187], v17, s[24:27], s62 offen
    s_add_u32 s62, s86, 65536
    buffer_load_dwordx4 v[188:191], v17, s[24:27], s62 offen
    s_add_u32 s62, s86, 32768
    buffer_load_dwordx4 v[192:195], v17, s[24:27], s62 offen
    s_add_u32 s62, s86, 98304
    buffer_load_dwordx4 v[196:199], v17, s[24:27], s62 offen
    s_barrier
    s_add_u32 m0, s92, 49152
    s_add_u32 s62, s83, 32768
    buffer_load_dwordx4 v18, s[24:27], s62 offen  lds
    s_addk_i32 m0, 4096
    s_add_u32 s62, s83, 98304
    buffer_load_dwordx4 v18, s[24:27], s62 offen  lds
    s_addk_i32 m0, 4096
    s_add_u32 s62, s84, 0
    buffer_load_dwordx4 v18, s[24:27], s62 offen  lds
    s_addk_i32 m0, 4096
    s_add_u32 s62, s84, 65536
    buffer_load_dwordx4 v18, s[24:27], s62 offen  lds
    s_addk_i32 m0, 4096
    s_add_u32 s62, s84, 32768
    buffer_load_dwordx4 v18, s[24:27], s62 offen  lds
    s_addk_i32 m0, 4096
    s_add_u32 s62, s84, 98304
    buffer_load_dwordx4 v18, s[24:27], s62 offen  lds
    s_addk_i32 m0, 4096
    s_add_u32 s62, s85, 0
    buffer_load_dwordx4 v18, s[24:27], s62 offen  lds
    s_addk_i32 m0, 4096
    s_add_u32 s62, s85, 65536
    buffer_load_dwordx4 v18, s[24:27], s62 offen  lds
    s_addk_i32 m0, 4096
    s_add_u32 s62, s85, 32768
    buffer_load_dwordx4 v18, s[24:27], s62 offen  lds
    s_addk_i32 m0, 4096
    s_add_u32 s62, s85, 98304
    buffer_load_dwordx4 v18, s[24:27], s62 offen  lds
    s_addk_i32 m0, 4096
    s_add_u32 s62, s86, 0
    buffer_load_dwordx4 v18, s[24:27], s62 offen  lds
    s_addk_i32 m0, 4096
    s_add_u32 s62, s86, 65536
    buffer_load_dwordx4 v18, s[24:27], s62 offen  lds
    s_barrier
    s_add_u32 m0, s92, 0
    s_add_u32 s62, s86, 32768
    buffer_load_dwordx4 v18, s[24:27], s62 offen  lds
    s_addk_i32 m0, 4096
    s_add_u32 s62, s86, 98304
    buffer_load_dwordx4 v18, s[24:27], s62 offen  lds
    s_addk_i32 m0, 4096
    s_add_u32 s62, s80, 0
    buffer_load_dwordx4 v17, s[24:27], s62 offen  lds
    s_addk_i32 m0, 4096
    s_add_u32 s62, s80, 65536
    buffer_load_dwordx4 v17, s[24:27], s62 offen  lds
    s_addk_i32 m0, 4096
    s_add_u32 s62, s80, 32768
    buffer_load_dwordx4 v17, s[24:27], s62 offen  lds
    s_addk_i32 m0, 4096
    s_add_u32 s62, s80, 98304
    buffer_load_dwordx4 v17, s[24:27], s62 offen  lds
    s_addk_i32 m0, 4096
    s_add_u32 s62, s81, 0
    buffer_load_dwordx4 v17, s[24:27], s62 offen  lds
    s_addk_i32 m0, 4096
    s_add_u32 s62, s81, 65536
    buffer_load_dwordx4 v17, s[24:27], s62 offen  lds
    s_waitcnt vmcnt(8)
    s_barrier
    s_cmp_lg_u32 s74, 0
    s_cbranch_scc1 L_nf_21
    s_atomic_add_x2 s[44:45], s[42:43], 0
L_nf_21:
    global_load_dword v24, v8, s[52:53] offset:128 sc1
    s_addk_i32 m0, 4096
    s_add_u32 s62, s81, 32768
    buffer_load_dwordx4 v17, s[24:27], s62 offen  lds
    s_addk_i32 m0, 4096
    s_add_u32 s62, s81, 98304
    buffer_load_dwordx4 v17, s[24:27], s62 offen  lds
    s_addk_i32 m0, 4096
    s_add_u32 s62, s82, 0
    buffer_load_dwordx4 v17, s[24:27], s62 offen  lds
    s_addk_i32 m0, 4096
    s_add_u32 s62, s82, 65536
    buffer_load_dwordx4 v17, s[24:27], s62 offen  lds
    s_waitcnt vmcnt(4)
    s_mov_b32 s89, 100000
L_poll_22:
    v_cmp_eq_u32 vcc, 0, v24
    s_cbranch_vccz L_ok_23
    s_sleep 4
    global_load_dword v24, v8, s[52:53] offset:128 sc1
    s_waitcnt vmcnt(0)
    s_sub_u32 s89, s89, 1
    s_cbranch_scc0 L_poll_22
L_ok_23:
    buffer_load_dwordx2 v[36:37], v19, s[20:23], s91 offen offset:0 sc1
    buffer_load_dwordx2 v[38:39], v19, s[20:23], s91 offen offset:128 sc1
    buffer_load_dwordx2 v[40:41], v19, s[20:23], s91 offen offset:1024 sc1
    buffer_load_dwordx2 v[42:43], v19, s[20:23], s91 offen offset:1152 sc1
    buffer_load_dwordx2 v[44:45], v19, s[20:23], s91 offen offset:2048 sc1
    buffer_load_dwordx2 v[46:47], v19, s[20:23], s91 offen offset:2176 sc1
    buffer_load_dwordx2 v[48:49], v19, s[20:23], s91 offen offset:3072 sc1
    buffer_load_dwordx2 v[50:51], v19, s[20:23], s91 offen offset:3200 sc1
    s_cmp_lg_u32 s74, 3
    s_cbranch_scc1 L_nw_24
    s_load_dwordx2 s[64:65], s[34:35], 0 glc
    s_load_dwordx2 s[66:67], s[34:35], 1024 glc
    s_load_dwordx2 s[68:69], s[34:35], 2048 glc
    s_load_dwordx2 s[70:71], s[34:35], 3072 glc
    s_load_dwordx2 s[72:73], s[34:35], 4096 glc
    s_load_dwordx2 s[76:77], s[34:35], 5120 glc
    s_load_dwordx2 s[78:79], s[34:35], 6144 glc
L_nw_24:
    s_branch L_ltail_18
L_lspec_17:
    s_addk_i32 m0, 4096
    s_add_u32 s62, s64, 1024
    buffer_load_dwordx4 v10, s[8:11], s62 offen  lds
    s_addk_i32 m0, 4096
    s_add_u32 s62, s64, 263168
    buffer_load_dwordx4 v10, s[8:11], s62 offen  lds
    s_addk_i32 m0, 4096
    s_add_u32 s62, s64, 525312
    buffer_load_dwordx4 v10, s[8:11], s62 offen  lds
    s_addk_i32 m0, 4096
    s_add_u32 s62, s64, 787456
    buffer_load_dwordx4 v10, s[8:11], s62 offen  lds
    s_waitcnt vmcnt(5)
    s_barrier
    s_addk_i32 m0, 4096
    s_add_u32 s62, s64, 1049600
    buffer_load_dwordx4 v10, s[8:11], s62 offen  lds
    s_addk_i32 m0, 4096
    s_add_u32 s62, s64, 1311744
    buffer_load_dwordx4 v10, s[8:11], s62 offen  lds
    s_addk_i32 m0, 4096
    s_add_u32 s62, s64, 1573888
    buffer_load_dwordx4 v10, s[8:11], s62 offen  lds
    s_addk_i32 m0, 4096
    s_add_u32 s62, s64, 1836032
    buffer_load_dwordx4 v10, s[8:11], s62 offen  lds
    s_load_dword s95, s[76:77], -458752
    s_load_dword s95, s[76:77], -458688
    s_load_dword s95, s[76:77], -458624
    s_load_dword s95, s[76:77], -458560
    s_load_dword s95, s[76:77], -458496
    s_load_dword s95, s[76:77], -458432
    s_load_dword s95, s[76:77], -458368
    s_load_dword s95, s[76:77], 0
    s_load_dword s95, s[76:77], 64
    s_load_dword s95, s[76:77], 128
    s_load_dword s95, s[76:77], 192
    s_load_dword s95, s[76:77], 256
    s_load_dword s95, s[76:77], 320
    s_load_dword s95, s[76:77], 384
    s_bitcmp1_b32 s93, 0
    s_cselect_b32 s80, 786432, s80
    s_cselect_b32 s81, 1048576, s81
    s_cselect_b32 s82, 1310720, s82
    s_cselect_b32 s83, 1572864, s83
    s_cselect_b32 s84, 0, s84
    s_cselect_b32 s85, 262144, s85
    s_cselect_b32 s86, 524288, s86
    v_lshrrev_b32 v5, 3, v255
    v_xor_b32 v6, v5, v255
    v_and_b32 v6, 7, v6
    v_lshlrev_b32 v6, 4, v6
    v_lshl_add_u32 v35, v5, 15, v6
    s_lshl_b32 s5, s74, 9
    s_add_u32 s5, s5, s59
    s_lshl3_add_u32 s5, s5, s3
    s_lshl_b32 s5, s5, 7
    s_lshl1_add_u32 s61, s57, s58
    s_sub_u32 s61, s61, 14
    s_lshl_b32 s61, s61, 6
    v_and_b32 v3, 7, v12
    v_lshl_add_u32 v3, v3, 2, v13
    v_lshrrev_b32 v4, 3, v12
    v_lshl_add_u32 v3, v3, 1, v4
    v_add_u32 v20, s61, v3
    v_lshlrev_b32 v20, 4, v20
    s_mov_b32 s87, 9437184
    v_lshl_add_u32 v21, v255, 4, s92
    v_add_u32 v23, 0x10000, v21
    v_add_u32 v34, 0x20000, v21
    s_lshl2_add_u32 s60, s3, s74
    s_lshl_b32 s60, s60, 4
    s_sub_u32 s61, 32, s59
    s_and_b32 s61, s61, 31
    v_add_u32 v3, s60, v12
    v_sub_u32 v4, 512, v3
    s_cmp_ge_u32 s3, 4
    s_cselect_b32 s61, s61, s59
    s_cselect_b64 vcc, -1, 0
    s_mul_i32 s61, s61, 69632
    s_add_u32 s91, s61, 10485760
    v_cndmask_b32 v4, v3, v4, vcc
    v_and_b32 v5, 64, v4
    v_cmp_ne_u32 vcc, 0, v5
    v_sub_u32 v5, 0, v4
    v_and_b32 v6, 0xc0, v4
    v_cndmask_b32 v4, v4, v5, vcc
    v_and_or_b32 v4, v4, 63, v6
    v_and_b32 v5, 15, v4
    v_lshrrev_b32 v4, 4, v4
    v_lshl_add_u32 v4, v4, 4, v13
    v_lshl_add_u32 v4, v4, 5, v5
    v_cmp_eq_u32 vcc, 0, v3
    v_lshlrev_b32 v4, 3, v4
    v_add_u32 v5, 0x10000, v4
    v_cndmask_b32 v19, v4, v5, vcc
    v_mov_b32 v8, 0
    s_lshr_b32 s61, s59, 1
    s_and_b32 s63, s59, 1
    s_lshl4_add_u32 s61, s61, s63
    s_lshl_b32 s61, s61, 9
    s_add_u32 s61, s61, 10223616
    s_xor_b32 s63, s61, 0x300
    s_add_u32 s34, s54, s61
    s_addc_u32 s35, s55, 0
    s_add_u32 s36, s54, s63
    s_addc_u32 s37, s55, 0
    s_waitcnt vmcnt(0)
    s_barrier
    v_readfirstlane_b32 s6, v9
    s_nop 0
    s_mul_i32 s6, s6, 0x9e3779b1
    s_add_u32 s6, s6, 0x7f4a7c15
    s_not_b32 s7, s6
    s_mov_b32 s89, 100000
L_rt_25:
    buffer_load_dwordx4 v[24:27], v20, s[20:23], s87 offen sc1
    s_waitcnt vmcnt(0)
    v_cmp_ne_u32 vcc, s6, v25
    s_cbranch_vccz L_ok_26
    s_sleep 4
    s_sub_u32 s89, s89, 1
    s_cbranch_scc0 L_rt_25
L_ok_26:
    v_lshlrev_b32 v3, 2, v255
    v_add_u32 v3, 157696, v3
    v_lshlrev_b32 v24, 16, v24
    ds_write_b32 v3, v27
    ds_write_b32 v3, v24 offset:256
    s_waitcnt lgkmcnt(0)
    s_load_dword s95, s[76:77], 458752
    s_load_dword s95, s[76:77], 458816
    s_load_dword s95, s[76:77], 458880
    s_load_dword s95, s[76:77], 458944
    s_load_dword s95, s[76:77], 459008
    s_load_dword s95, s[76:77], 459072
    s_load_dword s95, s[76:77], 459136
    s_add_u32 m0, s92, 98304
    s_add_u32 s62, s80, 0
    buffer_load_dwordx4 v18, s[24:27], s62 offen  lds
    s_addk_i32 m0, 4096
    s_add_u32 s62, s80, 65536
    buffer_load_dwordx4 v18, s[24:27], s62 offen  lds
    s_addk_i32 m0, 4096
    s_add_u32 s62, s80, 32768
    buffer_load_dwordx4 v18, s[24:27], s62 offen  lds
    s_addk_i32 m0, 4096
    s_add_u32 s62, s80, 98304
    buffer_load_dwordx4 v18, s[24:27], s62 offen  lds
    s_addk_i32 m0, 4096
    s_add_u32 s62, s81, 0
    buffer_load_dwordx4 v18, s[24:27], s62 offen  lds
    s_addk_i32 m0, 4096
    s_add_u32 s62, s81, 65536
    buffer_load_dwordx4 v18, s[24:27], s62 offen  lds
    s_barrier
    s_load_dword s95, s[76:77], -917504
    s_load_dword s95, s[76:77], -917440
    s_load_dword s95, s[76:77], -917376
    s_load_dword s95, s[76:77], -917312
    s_load_dword s95, s[76:77], -917248
    s_load_dword s95, s[76:77], -917184
    s_load_dword s95, s[76:77], -917120
    s_addk_i32 m0, 4096
    s_add_u32 s62, s81, 32768
    buffer_load_dwordx4 v18, s[24:27], s62 offen  lds
    s_addk_i32 m0, 4096
    s_add_u32 s62, s81, 98304
    buffer_load_dwordx4 v18, s[24:27], s62 offen  lds
    s_addk_i32 m0, 4096
    s_add_u32 s62, s82, 0
    buffer_load_dwordx4 v18, s[24:27], s62 offen  lds
    s_addk_i32 m0, 4096
    s_add_u32 s62, s82, 65536
    buffer_load_dwordx4 v18, s[24:27], s62 offen  lds
    s_addk_i32 m0, 4096
    s_add_u32 s62, s82, 32768
    buffer_load_dwordx4 v18, s[24:27], s62 offen  lds
    s_addk_i32 m0, 4096
    s_add_u32 s62, s82, 98304
    buffer_load_dwordx4 v18, s[24:27], s62 offen  lds
    s_addk_i32 m0, 4096
    s_add_u32 s62, s83, 0
    buffer_load_dwordx4 v18, s[24:27], s62 offen  lds
    s_addk_i32 m0, 4096
    s_add_u32 s62, s83, 65536
    buffer_load_dwordx4 v18, s[24:27], s62 offen  lds
    s_add_u32 s62, s82, 32768
    buffer_load_dwordx4 v[128:131], v17, s[24:27], s62 offen
    s_add_u32 s62, s82, 98304
    buffer_load_dwordx4 v[132:135], v17, s[24:27], s62 offen
    s_add_u32 s62, s83, 0
    buffer_load_dwordx4 v[136:139], v17, s[24:27], s62 offen
    s_add_u32 s62, s83, 65536
    buffer_load_dwordx4 v[140:143], v17, s[24:27], s62 offen
    s_add_u32 s62, s83, 32768
    buffer_load_dwordx4 v[144:147], v17, s[24:27], s62 offen
    s_add_u32 s62, s83, 98304
    buffer_load_dwordx4 v[148:151], v17, s[24:27], s62 offen
    s_add_u32 s62, s84, 0
    buffer_load_dwordx4 v[152:155], v17, s[24:27], s62 offen
    s_add_u32 s62, s84, 65536
    buffer_load_dwordx4 v[156:159], v17, s[24:27], s62 offen
    s_add_u32 s62, s84, 32768
    buffer_load_dwordx4 v[160:163], v17, s[24:27], s62 offen
    s_add_u32 s62, s84, 98304
    buffer_load_dwordx4 v[164:167], v17, s[24:27], s62 offen
    s_add_u32 s62, s85, 0
    buffer_load_dwordx4 v[168:171], v17, s[24:27], s62 offen
    s_add_u32 s62, s85, 65536
    buffer_load_dwordx4 v[172:175], v17, s[24:27], s62 offen
    buffer_load_dwordx4 v[52:55], v35, s[8:11], s5 offen
    s_add_u32 s5, s5, 0x40000
    buffer_load_dwordx4 v[56:59], v35, s[8:11], s5 offen
    v_lshlrev_b32 v60, 2, v13
    v_cvt_f32_u32 v60, v60
    v_lshl_add_u32 v61, v12, 5, s59
    v_cvt_f32_u32 v61, v61
    v_mul_f32 v61, s90, v61
    v_add_f32 v40, 0x0, v60
    v_mul_f32 v40, v40, v61
    v_add_f32 v41, v40, v61
    v_add_f32 v42, v41, v61
    v_add_f32 v43, v42, v61
    v_cos_f32 v44, v40
    v_sin_f32 v48, v40
    v_cos_f32 v45, v41
    v_sin_f32 v49, v41
    v_cos_f32 v46, v42
    v_sin_f32 v50, v42
    v_cos_f32 v47, v43
    v_sin_f32 v51, v43
    v_cvt_pk_bf16_f32 v64, v44, v48
    v_cvt_pk_bf16_f32 v65, v45, v49
    v_cvt_pk_bf16_f32 v66, v46, v50
    v_cvt_pk_bf16_f32 v67, v47, v51
    v_cvt_pk_bf16_f32 v40, v49, v45
    v_cvt_pk_bf16_f32 v41, v51, v47
    v_mov_b32 v80, v64
    v_mov_b32 v96, v64
    v_mov_b32 v112, v64
    v_xor_b32 v81, s75, v40
    v_xor_b32 v113, s73, v40
    v_xor_b32 v83, s73, v41
    v_xor_b32 v115, s75, v41
    v_xor_b32 v97, 0x80008000, v65
    v_xor_b32 v99, 0x80008000, v67
    v_xor_b32 v82, 0x80008000, v66
    v_mov_b32 v98, v66
    v_mov_b32 v114, v82
    v_add_f32 v40, 0x41800000, v60
    v_mul_f32 v40, v40, v61
    v_add_f32 v41, v40, v61
    v_add_f32 v42, v41, v61
    v_add_f32 v43, v42, v61
    v_cos_f32 v44, v40
    v_sin_f32 v48, v40
    v_cos_f32 v45, v41
    v_sin_f32 v49, v41
    v_cos_f32 v46, v42
    v_sin_f32 v50, v42
    v_cos_f32 v47, v43
    v_sin_f32 v51, v43
    v_cvt_pk_bf16_f32 v68, v44, v48
    v_cvt_pk_bf16_f32 v69, v45, v49
    v_cvt_pk_bf16_f32 v70, v46, v50
    v_cvt_pk_bf16_f32 v71, v47, v51
    v_cvt_pk_bf16_f32 v40, v49, v45
    v_cvt_pk_bf16_f32 v41, v51, v47
    v_mov_b32 v84, v68
    v_mov_b32 v100, v68
    v_mov_b32 v116, v68
    v_xor_b32 v85, s75, v40
    v_xor_b32 v117, s73, v40
    v_xor_b32 v87, s73, v41
    v_xor_b32 v119, s75, v41
    v_xor_b32 v101, 0x80008000, v69
    v_xor_b32 v103, 0x80008000, v71
    v_xor_b32 v86, 0x80008000, v70
    v_mov_b32 v102, v70
    v_mov_b32 v118, v86
    v_add_f32 v40, 0x42000000, v60
    v_mul_f32 v40, v40, v61
    v_add_f32 v41, v40, v61
    v_add_f32 v42, v41, v61
    v_add_f32 v43, v42, v61
    v_cos_f32 v44, v40
    v_sin_f32 v48, v40
    v_cos_f32 v45, v41
    v_sin_f32 v49, v41
    v_cos_f32 v46, v42
    v_sin_f32 v50, v42
    v_cos_f32 v47, v43
    v_sin_f32 v51, v43
    v_cvt_pk_bf16_f32 v72, v44, v48
    v_cvt_pk_bf16_f32 v73, v45, v49
    v_cvt_pk_bf16_f32 v74, v46, v50
    v_cvt_pk_bf16_f32 v75, v47, v51
    v_cvt_pk_bf16_f32 v40, v49, v45
    v_cvt_pk_bf16_f32 v41, v51, v47
    v_mov_b32 v88, v72
    v_mov_b32 v104, v72
    v_mov_b32 v120, v72
    v_xor_b32 v89, s75, v40
    v_xor_b32 v121, s73, v40
    v_xor_b32 v91, s73, v41
    v_xor_b32 v123, s75, v41
    v_xor_b32 v105, 0x80008000, v73
    v_xor_b32 v107, 0x80008000, v75
    v_xor_b32 v90, 0x80008000, v74
    v_mov_b32 v106, v74
    v_mov_b32 v122, v90
    v_add_f32 v40, 0x42400000, v60
    v_mul_f32 v40, v40, v61
    v_add_f32 v41, v40, v61
    v_add_f32 v42, v41, v61
    v_add_f32 v43, v42, v61
    v_cos_f32 v44, v40
    v_sin_f32 v48, v40
    v_cos_f32 v45, v41
    v_sin_f32 v49, v41
    v_cos_f32 v46, v42
    v_sin_f32 v50, v42
    v_cos_f32 v47, v43
    v_sin_f32 v51, v43
    v_cvt_pk_bf16_f32 v76, v44, v48
    v_cvt_pk_bf16_f32 v77, v45, v49
    v_cvt_pk_bf16_f32 v78, v46, v50
    v_cvt_pk_bf16_f32 v79, v47, v51
    v_cvt_pk_bf16_f32 v40, v49, v45
    v_cvt_pk_bf16_f32 v41, v51, v47
    v_mov_b32 v92, v76
    v_mov_b32 v108, v76
    v_mov_b32 v124, v76
    v_xor_b32 v93, s75, v40
    v_xor_b32 v125, s73, v40
    v_xor_b32 v95, s73, v41
    v_xor_b32 v127, s75, v41
    v_xor_b32 v109, 0x80008000, v77
    v_xor_b32 v111, 0x80008000, v79
    v_xor_b32 v94, 0x80008000, v78
    v_mov_b32 v110, v78
    v_mov_b32 v126, v94
    s_barrier
    s_cmp_lg_u32 s74, 0
    s_cbranch_scc1 L_nf_27
    s_mov_b32 s44, 1
    s_atomic_add s44, s[52:53], 0 glc
    s_waitcnt lgkmcnt(0)
    s_cmp_lg_u32 s44, 31
    s_cbranch_scc1 L_nf_27
    s_atomic_add s44, s[52:53], 128
L_nf_27:
    s_add_u32 s62, s85, 32768
    buffer_load_dwordx4 v[176:179], v17, s[24:27], s62 offen
    s_add_u32 s62, s85, 98304
    buffer_load_dwordx4 v[180:183], v17, s[24:27], s62 offen
    s_add_u32 s62, s86, 0
    buffer_load_dwordx4 v[184:187], v17, s[24:27], s62 offen
    s_add_u32 s62, s86, 65536
    buffer_load_dwordx4 v[188:191], v17, s[24:27], s62 offen
    s_add_u32 s62, s86, 32768
    buffer_load_dwordx4 v[192:195], v17, s[24:27], s62 offen
    s_add_u32 s62, s86, 98304
    buffer_load_dwordx4 v[196:199], v17, s[24:27], s62 offen
    s_add_u32 m0, s92, 49152
    s_add_u32 s62, s83, 32768
    buffer_load_dwordx4 v18, s[24:27], s62 offen  lds
    s_addk_i32 m0, 4096
    s_add_u32 s62, s83, 98304
    buffer_load_dwordx4 v18, s[24:27], s62 offen  lds
    s_addk_i32 m0, 4096
    s_add_u32 s62, s84, 0
    buffer_load_dwordx4 v18, s[24:27], s62 offen  lds
    s_addk_i32 m0, 4096
    s_add_u32 s62, s84, 65536
    buffer_load_dwordx4 v18, s[24:27], s62 offen  lds
    s_addk_i32 m0, 4096
    s_add_u32 s62, s84, 32768
    buffer_load_dwordx4 v18, s[24:27], s62 offen  lds
    s_addk_i32 m0, 4096
    s_add_u32 s62, s84, 98304
    buffer_load_dwordx4 v18, s[24:27], s62 offen  lds
    s_addk_i32 m0, 4096
    s_add_u32 s62, s85, 0
    buffer_load_dwordx4 v18, s[24:27], s62 offen  lds
    s_addk_i32 m0, 4096
    s_add_u32 s62, s85, 65536
    buffer_load_dwordx4 v18, s[24:27], s62 offen  lds
    s_addk_i32 m0, 4096
    s_add_u32 s62, s85, 32768
    buffer_load_dwordx4 v18, s[24:27], s62 offen  lds
    s_addk_i32 m0, 4096
    s_add_u32 s62, s85, 98304
    buffer_load_dwordx4 v18, s[24:27], s62 offen  lds
    s_addk_i32 m0, 4096
    s_add_u32 s62, s86, 0
    buffer_load_dwordx4 v18, s[24:27], s62 offen  lds
    s_addk_i32 m0, 4096
    s_add_u32 s62, s86, 65536
    buffer_load_dwordx4 v18, s[24:27], s62 offen  lds
    s_add_u32 m0, s92, 0
    s_add_u32 s62, s86, 32768
    buffer_load_dwordx4 v18, s[24:27], s62 offen  lds
    s_addk_i32 m0, 4096
    s_add_u32 s62, s86, 98304
    buffer_load_dwordx4 v18, s[24:27], s62 offen  lds
    s_addk_i32 m0, 4096
    s_add_u32 s62, s80, 0
    buffer_load_dwordx4 v17, s[24:27], s62 offen  lds
    s_addk_i32 m0, 4096
    s_add_u32 s62, s80, 65536
    buffer_load_dwordx4 v17, s[24:27], s62 offen  lds
    s_addk_i32 m0, 4096
    s_add_u32 s62, s80, 32768
    buffer_load_dwordx4 v17, s[24:27], s62 offen  lds
    s_addk_i32 m0, 4096
    s_add_u32 s62, s80, 98304
    buffer_load_dwordx4 v17, s[24:27], s62 offen  lds
    s_addk_i32 m0, 4096
    s_add_u32 s62, s81, 0
    buffer_load_dwordx4 v17, s[24:27], s62 offen  lds
    s_addk_i32 m0, 4096
    s_add_u32 s62, s81, 65536
    buffer_load_dwordx4 v17, s[24:27], s62 offen  lds
    s_addk_i32 m0, 4096
    s_add_u32 s62, s81, 32768
    buffer_load_dwordx4 v17, s[24:27], s62 offen  lds
    s_addk_i32 m0, 4096
    s_add_u32 s62, s81, 98304
    buffer_load_dwordx4 v17, s[24:27], s62 offen  lds
    s_addk_i32 m0, 4096
    s_add_u32 s62, s82, 0
    buffer_load_dwordx4 v17, s[24:27], s62 offen  lds
    s_addk_i32 m0, 4096
    s_add_u32 s62, s82, 65536
    buffer_load_dwordx4 v17, s[24:27], s62 offen  lds
    global_load_dword v24, v8, s[52:53] offset:128 sc1
    s_waitcnt vmcnt(0)
    s_mov_b32 s89, 100000
L_poll_28:
    v_cmp_eq_u32 vcc, 0, v24
    s_cbranch_vccz L_ok_29
    s_sleep 4
    global_load_dword v24, v8, s[52:53] offset:128 sc1
    s_waitcnt vmcnt(0)
    s_sub_u32 s89, s89, 1
    s_cbranch_scc0 L_poll_28
L_ok_29:
    buffer_load_dwordx2 v[36:37], v19, s[20:23], s91 offen offset:0 sc1
    buffer_load_dwordx2 v[38:39], v19, s[20:23], s91 offen offset:128 sc1
    buffer_load_dwordx2 v[40:41], v19, s[20:23], s91 offen offset:1024 sc1
    buffer_load_dwordx2 v[42:43], v19, s[20:23], s91 offen offset:1152 sc1
    buffer_load_dwordx2 v[44:45], v19, s[20:23], s91 offen offset:2048 sc1
    buffer_load_dwordx2 v[46:47], v19, s[20:23], s91 offen offset:2176 sc1
    buffer_load_dwordx2 v[48:49], v19, s[20:23], s91 offen offset:3072 sc1
    buffer_load_dwordx2 v[50:51], v19, s[20:23], s91 offen offset:3200 sc1
    s_waitcnt vmcnt(9)
    s_barrier
    s_cmp_lg_u32 s74, 3
    s_cbranch_scc1 L_nw_30
    s_load_dwordx2 s[64:65], s[34:35], 0 glc
    s_load_dwordx2 s[66:67], s[34:35], 1024 glc
    s_load_dwordx2 s[68:69], s[34:35], 2048 glc
    s_load_dwordx2 s[70:71], s[34:35], 3072 glc
    s_load_dwordx2 s[72:73], s[34:35], 4096 glc
    s_load_dwordx2 s[76:77], s[34:35], 5120 glc
    s_load_dwordx2 s[78:79], s[34:35], 6144 glc
L_nw_30:
L_ltail_18:
    s_cmp_lg_u32 s74, 3
    s_cbranch_scc1 L_nopoll_31
    s_mov_b32 s89, 100000
    s_branch L_chk_33
L_poll_32:
    s_load_dwordx2 s[64:65], s[34:35], 0 glc
    s_load_dwordx2 s[66:67], s[34:35], 1024 glc
    s_load_dwordx2 s[68:69], s[34:35], 2048 glc
    s_load_dwordx2 s[70:71], s[34:35], 3072 glc
    s_load_dwordx2 s[72:73], s[34:35], 4096 glc
    s_load_dwordx2 s[76:77], s[34:35], 5120 glc
    s_load_dwordx2 s[78:79], s[34:35], 6144 glc
    s_sub_u32 s89, s89, 1
    s_cbranch_scc1 L_nopoll_31
L_chk_33:
    s_waitcnt lgkmcnt(0)
    s_cmp_lg_u64 s[64:65], s[6:7]
    s_cbranch_scc1 L_poll_32
    s_cmp_lg_u64 s[66:67], s[6:7]
    s_cbranch_scc1 L_poll_32
    s_cmp_lg_u64 s[68:69], s[6:7]
    s_cbranch_scc1 L_poll_32
    s_cmp_lg_u64 s[70:71], s[6:7]
    s_cbranch_scc1 L_poll_32
    s_cmp_lg_u64 s[72:73], s[6:7]
    s_cbranch_scc1 L_poll_32
    s_cmp_lg_u64 s[76:77], s[6:7]
    s_cbranch_scc1 L_poll_32
    s_cmp_lg_u64 s[78:79], s[6:7]
    s_cbranch_scc1 L_poll_32
L_nopoll_31:
    s_barrier
    s_waitcnt vmcnt(0) lgkmcnt(0)
    v_mfma_f32_16x16x32_bf16 v[224:227], v[36:39], v[64:67], 0
    v_mfma_f32_16x16x32_bf16 v[228:231], v[36:39], v[80:83], 0
    v_mfma_f32_16x16x32_bf16 v[232:235], v[36:39], v[96:99], 0
    v_mfma_f32_16x16x32_bf16 v[236:239], v[36:39], v[112:115], 0
    v_mfma_f32_16x16x32_bf16 v[224:227], v[40:43], v[68:71], v[224:227]
    v_mfma_f32_16x16x32_bf16 v[228:231], v[40:43], v[84:87], v[228:231]
    v_mfma_f32_16x16x32_bf16 v[232:235], v[40:43], v[100:103], v[232:235]
    v_mfma_f32_16x16x32_bf16 v[236:239], v[40:43], v[116:119], v[236:239]
    v_mfma_f32_16x16x32_bf16 v[224:227], v[44:47], v[72:75], v[224:227]
    v_mfma_f32_16x16x32_bf16 v[228:231], v[44:47], v[88:91], v[228:231]
    v_mfma_f32_16x16x32_bf16 v[232:235], v[44:47], v[104:107], v[232:235]
    v_mfma_f32_16x16x32_bf16 v[236:239], v[44:47], v[120:123], v[236:239]
    v_mfma_f32_16x16x32_bf16 v[224:227], v[48:51], v[76:79], v[224:227]
    v_mfma_f32_16x16x32_bf16 v[228:231], v[48:51], v[92:95], v[228:231]
    v_mfma_f32_16x16x32_bf16 v[232:235], v[48:51], v[108:111], v[232:235]
    v_mfma_f32_16x16x32_bf16 v[236:239], v[48:51], v[124:127], v[236:239]
    s_barrier
    s_cmp_ge_u32 s58, 14
    s_cbranch_scc1 L_nf_34
    s_cmp_lg_u32 s74, 0
    s_cbranch_scc1 L_nf_34
    s_atomic_add_x2 s[46:47], s[42:43], 256
L_nf_34:
    ds_write_b128 v23, v[128:131] offset:32768
    ds_write_b128 v23, v[132:135] offset:36864
    ds_write_b128 v23, v[136:139] offset:40960
    ds_write_b128 v23, v[140:143] offset:45056
    ds_write_b128 v23, v[144:147] offset:49152
    ds_write_b128 v23, v[148:151] offset:53248
    ds_write_b128 v23, v[152:155] offset:57344
    ds_write_b128 v23, v[156:159] offset:61440
    ds_write_b128 v34, v[160:163] offset:0
    ds_write_b128 v34, v[164:167] offset:4096
    ds_write_b128 v34, v[168:171] offset:8192
    ds_write_b128 v34, v[172:175] offset:12288
    s_cmp_lg_u32 s74, 3
    s_cbranch_scc1 L_nw_35
    s_load_dwordx2 s[64:65], s[36:37], 0 glc
    s_load_dwordx2 s[66:67], s[36:37], 1024 glc
    s_load_dwordx2 s[68:69], s[36:37], 2048 glc
    s_load_dwordx2 s[70:71], s[36:37], 3072 glc
    s_load_dwordx2 s[72:73], s[36:37], 4096 glc
    s_load_dwordx2 s[76:77], s[36:37], 5120 glc
    s_load_dwordx2 s[78:79], s[36:37], 6144 glc
L_nw_35:
    ds_write_b128 v34, v[176:179] offset:16384
    ds_write_b128 v34, v[180:183] offset:20480
    ds_write_b128 v21, v[184:187] offset:49152
    ds_write_b128 v21, v[188:191] offset:53248
    ds_write_b128 v21, v[192:195] offset:57344
    ds_write_b128 v21, v[196:199] offset:61440
    s_cmp_lg_u32 s74, 3
    s_cbranch_scc1 L_nopoll_36
    s_mov_b32 s89, 100000
    s_branch L_chk_38
L_poll_37:
    s_load_dwordx2 s[64:65], s[36:37], 0 glc
    s_load_dwordx2 s[66:67], s[36:37], 1024 glc
    s_load_dwordx2 s[68:69], s[36:37], 2048 glc
    s_load_dwordx2 s[70:71], s[36:37], 3072 glc
    s_load_dwordx2 s[72:73], s[36:37], 4096 glc
    s_load_dwordx2 s[76:77], s[36:37], 5120 glc
    s_load_dwordx2 s[78:79], s[36:37], 6144 glc
    s_sub_u32 s89, s89, 1
    s_cbranch_scc1 L_nopoll_36
L_chk_38:
    s_waitcnt lgkmcnt(0)
    s_cmp_lg_u64 s[64:65], s[6:7]
    s_cbranch_scc1 L_poll_37
    s_cmp_lg_u64 s[66:67], s[6:7]
    s_cbranch_scc1 L_poll_37
    s_cmp_lg_u64 s[68:69], s[6:7]
    s_cbranch_scc1 L_poll_37
    s_cmp_lg_u64 s[70:71], s[6:7]
    s_cbranch_scc1 L_poll_37
    s_cmp_lg_u64 s[72:73], s[6:7]
    s_cbranch_scc1 L_poll_37
    s_cmp_lg_u64 s[76:77], s[6:7]
    s_cbranch_scc1 L_poll_37
    s_cmp_lg_u64 s[78:79], s[6:7]
    s_cbranch_scc1 L_poll_37
L_nopoll_36:
    s_barrier
    v_add_u32 v1, s92, v34
    ds_write_b128 v1, v[52:55] offset:24576
    ds_write_b128 v1, v[56:59] offset:25600
    s_or_b32 s60, s2, s74
    s_cbranch_scc1 L_nobump_39
    s_mov_b32 s60, 9535488
    v_mov_b32 v24, s6
    s_mov_b64 exec, 1
    buffer_store_dword v24, off, s[20:23], s60 sc1
    s_mov_b64 exec, -1
L_nobump_39:
    s_lshl_b32 s60, s74, 12
    s_add_u32 s60, s60, 65536
    v_lshl_add_u32 v1, v255, 4, s60
    s_waitcnt lgkmcnt(0)
    s_barrier
    ds_write_b128 v1, v[224:227] offset:0
    ds_write_b128 v1, v[228:231] offset:1024
    ds_write_b128 v1, v[232:235] offset:2048
    ds_write_b128 v1, v[236:239] offset:3072
    s_waitcnt lgkmcnt(0)
    s_barrier
    s_endpgm
L_rt_8:
    s_mul_i32 s68, s61, 14336
    s_mul_i32 s62, s69, 7168
    s_add_u32 s68, s68, s62
    s_lshl_b32 s62, s63, 8
    s_add_u32 s68, s68, s62
    s_add_u32 s68, s68, 9469952
    s_branch L_rz_9
L_r1b_12:
    s_lshl3_add_u32 s68, s70, s71
    s_lshl_b32 s68, s68, 7
    s_add_u32 s68, s68, 9437184
    s_lshl4_add_u32 s68, s60, s68
    s_mov_b32 s87, 1
    s_branch L_rz_9
L_r3_6:
    s_and_b32 s71, s93, 7
    s_lshr_b32 s70, s93, 3
    s_lshl2_add_u32 s70, s100, s70
    s_and_b32 s62, s101, 1
    s_lshl3_add_u32 s70, s62, s70
    s_lshr_b32 s62, s101, 1
    s_lshl1_add_u32 s70, s70, s62
    s_lshl3_add_u32 s72, s70, s71
    s_lshl_b32 s72, s72, 7
    s_add_u32 s72, s72, 9437184
    v_mov_b32 v1, s72
    s_waitcnt lgkmcnt(0)
    global_load_dword v252, v1, s[54:55] sc1
    s_mov_b32 s87, 2
L_rz_9:
    v_mov_b32 v253, 1073741824
    s_and_b32 s60, s2, 7
    s_bfe_u32 s62, s93, 0x10001
    s_lshl1_add_u32 s59, s60, s62
    s_sub_u32 s62, 32, s59
    s_cmp_eq_u32 s59, 0
    s_cselect_b32 s62, 16, s62
    s_bitcmp1_b32 s93, 0
    s_cselect_b32 s59, s62, s59
    s_lshr_b32 s3, s93, 2
    s_xor_b32 s3, s3, 4
    s_mov_b64 s[8:9], s[32:33]
    s_mov_b32 s10, 2097152
    s_mov_b32 s11, 0x00020000
    s_mov_b64 s[20:21], s[54:55]
    s_mov_b32 s22, 13107200
    s_mov_b32 s23, 0x00020000
    s_mov_b64 s[28:29], s[50:51]
    s_mov_b32 s30, 2097152
    s_mov_b32 s31, 0x00020000
    s_lshr_b32 s74, s56, 1
    s_and_b32 s75, s56, 1
    s_lshl_b32 s62, s75, 10
    s_add_u32 s62, s62, s59
    s_lshl3_add_u32 s62, s62, s3
    s_lshl1_add_u32 s62, s62, s74
    s_lshl_b32 s77, s62, 6
    s_add_u32 s78, s77, 524288
    s_lshl1_add_u32 s62, s59, s75
    s_mul_i32 s79, s62, 114688
    s_and_b32 s63, s59, 1
    s_lshl1_add_u32 s62, s63, s74
    s_lshl_b32 s62, s62, 11
    s_add_u32 s79, s79, s62
    s_mov_b32 s80, 0
    s_mov_b32 s81, 8192
    s_mov_b32 s82, 16384
    s_mov_b32 s83, 24576
    s_mov_b32 s84, 32768
    s_mov_b32 s85, 40960
    s_mov_b32 s86, 49152
    s_cmp_ge_u32 s58, 14
    s_cbranch_scc1 L_sp0_40
    v_and_b32 v129, 15, v255
    v_lshrrev_b32 v130, 4, v255
    v_lshrrev_b32 v131, 1, v129
    v_xor_b32 v131, v131, v130
    v_lshlrev_b32 v131, 4, v131
    v_lshl_add_u32 v224, v129, 7, v131
    v_xor_b32 v225, 64, v224
    s_mov_b32 s73, 49152
    v_lshrrev_b32 v131, 2, v129
    v_and_b32 v132, 3, v129
    v_and_b32 v133, 1, v130
    v_lshl_or_b32 v133, v133, 2, v131
    s_lshl_b32 s62, s56, 1
    v_xor_b32 v133, s62, v133
    v_lshlrev_b32 v133, 5, v133
    v_lshl_add_u32 v133, v132, 3, v133
    v_lshl_add_u32 v131, v130, 3, v131
    v_lshl_add_u32 v226, v131, 8, v133
    v_xor_b32 v227, 32, v226
    v_lshlrev_b32 v229, 4, v129
    v_add_u32 v229, 155648, v229
    v_and_b32 v131, 1, v130
    v_lshl_add_u32 v228, v131, 4, v129
    v_lshrrev_b32 v131, 1, v130
    v_lshl_add_u32 v228, v131, 7, v228
    s_lshl_b32 s62, s56, 5
    v_add_u32 v228, s62, v228
    v_lshlrev_b32 v228, 2, v228
    v_add_u32 v228, 158208, v228
    v_lshlrev_b32 v230, 4, v255
    s_mul_i32 s62, s57, 448
    s_lshl2_add_u32 s62, s58, s62
    s_add_u32 s62, s62, s56
    s_lshl_b32 s62, s62, 10
    s_add_u32 s63, s62, 229376
    s_bitcmp1_b32 s58, 0
    s_cselect_b32 s90, s63, s62
    s_cselect_b32 s92, s62, s63
    s_branch L_j0_41
L_sp0_40:
    v_and_b32 v129, 15, v255
    v_lshrrev_b32 v130, 4, v255
    v_and_b32 v131, 3, v129
    v_lshrrev_b32 v132, 2, v129
    v_and_b32 v133, 1, v131
    v_lshrrev_b32 v134, 1, v131
    v_lshl_or_b32 v133, v134, 2, v133
    v_lshlrev_b32 v134, 1, v130
    v_xor_b32 v133, v133, v134
    v_lshlrev_b32 v133, 5, v133
    v_lshl_add_u32 v133, v132, 3, v133
    v_lshl_add_u32 v224, v131, 10, v133
    v_xor_b32 v225, 32, v224
    v_lshl_add_u32 v131, s56, 4, v129
    v_lshlrev_b32 v227, 6, v130
    v_add_u32 v227, 157696, v227
    v_cvt_f32_u32 v131, v131
    v_mul_f32 v131, 0xbb000000, v131
    v_add_f32 v132, v131, v131
    v_add_f32 v133, v132, v131
    v_mov_b32 v152, 1.0
    v_mov_b32 v156, 0
    v_cos_f32 v153, v131
    v_sin_f32 v157, v131
    v_cos_f32 v154, v132
    v_sin_f32 v158, v132
    v_cos_f32 v155, v133
    v_sin_f32 v159, v133
    v_cvt_f32_u32 v130, v130
    v_cvt_f32_u32 v129, v129
    v_mul_f32 v131, 4.0, v131
    v_mul_f32 v133, 0x41000000, v130
    v_add_f32 v132, 0x0, v133
    v_mul_f32 v132, v132, v131
    v_cos_f32 v136, v132
    v_sin_f32 v144, v132
    v_add_f32 v132, v132, v131
    v_cos_f32 v137, v132
    v_sin_f32 v145, v132
    v_add_f32 v132, v132, v131
    v_cos_f32 v138, v132
    v_sin_f32 v146, v132
    v_add_f32 v132, v132, v131
    v_cos_f32 v139, v132
    v_sin_f32 v147, v132
    v_add_f32 v132, v132, v131
    v_cos_f32 v140, v132
    v_sin_f32 v148, v132
    v_add_f32 v132, v132, v131
    v_cos_f32 v141, v132
    v_sin_f32 v149, v132
    v_add_f32 v132, v132, v131
    v_cos_f32 v142, v132
    v_sin_f32 v150, v132
    v_add_f32 v132, v132, v131
    v_cos_f32 v143, v132
    v_sin_f32 v151, v132
    v_cvt_pk_bf16_f32 v192, v136, v137
    v_cvt_pk_bf16_f32 v208, v144, v145
    v_cvt_pk_bf16_f32 v193, v138, v139
    v_cvt_pk_bf16_f32 v209, v146, v147
    v_cvt_pk_bf16_f32 v194, v140, v141
    v_cvt_pk_bf16_f32 v210, v148, v149
    v_cvt_pk_bf16_f32 v195, v142, v143
    v_cvt_pk_bf16_f32 v211, v150, v151
    v_add_f32 v132, 0x42000000, v133
    v_mul_f32 v132, v132, v131
    v_cos_f32 v136, v132
    v_sin_f32 v144, v132
    v_add_f32 v132, v132, v131
    v_cos_f32 v137, v132
    v_sin_f32 v145, v132
    v_add_f32 v132, v132, v131
    v_cos_f32 v138, v132
    v_sin_f32 v146, v132
    v_add_f32 v132, v132, v131
    v_cos_f32 v139, v132
    v_sin_f32 v147, v132
    v_add_f32 v132, v132, v131
    v_cos_f32 v140, v132
    v_sin_f32 v148, v132
    v_add_f32 v132, v132, v131
    v_cos_f32 v141, v132
    v_sin_f32 v149, v132
    v_add_f32 v132, v132, v131
    v_cos_f32 v142, v132
    v_sin_f32 v150, v132
    v_add_f32 v132, v132, v131
    v_cos_f32 v143, v132
    v_sin_f32 v151, v132
    v_cvt_pk_bf16_f32 v196, v136, v137
    v_cvt_pk_bf16_f32 v212, v144, v145
    v_cvt_pk_bf16_f32 v197, v138, v139
    v_cvt_pk_bf16_f32 v213, v146, v147
    v_cvt_pk_bf16_f32 v198, v140, v141
    v_cvt_pk_bf16_f32 v214, v148, v149
    v_cvt_pk_bf16_f32 v199, v142, v143
    v_cvt_pk_bf16_f32 v215, v150, v151
    v_add_f32 v132, 0x42800000, v133
    v_mul_f32 v132, v132, v131
    v_cos_f32 v136, v132
    v_sin_f32 v144, v132
    v_add_f32 v132, v132, v131
    v_cos_f32 v137, v132
    v_sin_f32 v145, v132
    v_add_f32 v132, v132, v131
    v_cos_f32 v138, v132
    v_sin_f32 v146, v132
    v_add_f32 v132, v132, v131
    v_cos_f32 v139, v132
    v_sin_f32 v147, v132
    v_add_f32 v132, v132, v131
    v_cos_f32 v140, v132
    v_sin_f32 v148, v132
    v_add_f32 v132, v132, v131
    v_cos_f32 v141, v132
    v_sin_f32 v149, v132
    v_add_f32 v132, v132, v131
    v_cos_f32 v142, v132
    v_sin_f32 v150, v132
    v_add_f32 v132, v132, v131
    v_cos_f32 v143, v132
    v_sin_f32 v151, v132
    v_cvt_pk_bf16_f32 v200, v136, v137
    v_cvt_pk_bf16_f32 v216, v144, v145
    v_cvt_pk_bf16_f32 v201, v138, v139
    v_cvt_pk_bf16_f32 v217, v146, v147
    v_cvt_pk_bf16_f32 v202, v140, v141
    v_cvt_pk_bf16_f32 v218, v148, v149
    v_cvt_pk_bf16_f32 v203, v142, v143
    v_cvt_pk_bf16_f32 v219, v150, v151
    v_add_f32 v132, 0x42c00000, v133
    v_mul_f32 v132, v132, v131
    v_cos_f32 v136, v132
    v_sin_f32 v144, v132
    v_add_f32 v132, v132, v131
    v_cos_f32 v137, v132
    v_sin_f32 v145, v132
    v_add_f32 v132, v132, v131
    v_cos_f32 v138, v132
    v_sin_f32 v146, v132
    v_add_f32 v132, v132, v131
    v_cos_f32 v139, v132
    v_sin_f32 v147, v132
    v_add_f32 v132, v132, v131
    v_cos_f32 v140, v132
    v_sin_f32 v148, v132
    v_add_f32 v132, v132, v131
    v_cos_f32 v141, v132
    v_sin_f32 v149, v132
    v_add_f32 v132, v132, v131
    v_cos_f32 v142, v132
    v_sin_f32 v150, v132
    v_add_f32 v132, v132, v131
    v_cos_f32 v143, v132
    v_sin_f32 v151, v132
    v_cvt_pk_bf16_f32 v204, v136, v137
    v_cvt_pk_bf16_f32 v220, v144, v145
    v_cvt_pk_bf16_f32 v205, v138, v139
    v_cvt_pk_bf16_f32 v221, v146, v147
    v_cvt_pk_bf16_f32 v206, v140, v141
    v_cvt_pk_bf16_f32 v222, v148, v149
    v_cvt_pk_bf16_f32 v207, v142, v143
    v_cvt_pk_bf16_f32 v223, v150, v151
    s_cmp_eq_u32 s56, 0
    s_cselect_b32 s40, 0x00010001, 0
    s_mov_b32 s41, s40
    v_mov_b32 v132, 0xbf803f80
    v_cndmask_b32 v208, v208, v132, s[40:41]
    v_cndmask_b32 v209, v209, v132, s[40:41]
    v_cndmask_b32 v210, v210, v132, s[40:41]
    v_cndmask_b32 v211, v211, v132, s[40:41]
    v_cndmask_b32 v212, v212, v132, s[40:41]
    v_cndmask_b32 v213, v213, v132, s[40:41]
    v_cndmask_b32 v214, v214, v132, s[40:41]
    v_cndmask_b32 v215, v215, v132, s[40:41]
    v_cndmask_b32 v216, v216, v132, s[40:41]
    v_cndmask_b32 v217, v217, v132, s[40:41]
    v_cndmask_b32 v218, v218, v132, s[40:41]
    v_cndmask_b32 v219, v219, v132, s[40:41]
    v_cndmask_b32 v220, v220, v132, s[40:41]
    v_cndmask_b32 v221, v221, v132, s[40:41]
    v_cndmask_b32 v222, v222, v132, s[40:41]
    v_cndmask_b32 v223, v223, v132, s[40:41]
    v_add_f32 v131, 0x0, v129
    v_mul_f32 v131, 0x3d000000, v131
    v_add_f32 v132, 0x0, v130
    v_mul_f32 v132, v132, v131
    v_cos_f32 v136, v132
    v_sin_f32 v144, v132
    v_add_f32 v132, 0x40800000, v130
    v_mul_f32 v132, v132, v131
    v_cos_f32 v137, v132
    v_sin_f32 v145, v132
    v_add_f32 v132, 0x41000000, v130
    v_mul_f32 v132, v132, v131
    v_cos_f32 v138, v132
    v_sin_f32 v146, v132
    v_add_f32 v132, 0x41400000, v130
    v_mul_f32 v132, v132, v131
    v_cos_f32 v139, v132
    v_sin_f32 v147, v132
    v_add_f32 v132, 0x41800000, v130
    v_mul_f32 v132, v132, v131
    v_cos_f32 v140, v132
    v_sin_f32 v148, v132
    v_add_f32 v132, 0x41a00000, v130
    v_mul_f32 v132, v132, v131
    v_cos_f32 v141, v132
    v_sin_f32 v149, v132
    v_add_f32 v132, 0x41c00000, v130
    v_mul_f32 v132, v132, v131
    v_cos_f32 v142, v132
    v_sin_f32 v150, v132
    v_add_f32 v132, 0x41e00000, v130
    v_mul_f32 v132, v132, v131
    v_cos_f32 v143, v132
    v_sin_f32 v151, v132
    v_cvt_pk_bf16_f32 v228, v136, v137
    v_cvt_pk_bf16_f32 v236, v144, v145
    v_xor_b32 v244, 0x80008000, v236
    v_cvt_pk_bf16_f32 v229, v138, v139
    v_cvt_pk_bf16_f32 v237, v146, v147
    v_xor_b32 v245, 0x80008000, v237
    v_cvt_pk_bf16_f32 v230, v140, v141
    v_cvt_pk_bf16_f32 v238, v148, v149
    v_xor_b32 v246, 0x80008000, v238
    v_cvt_pk_bf16_f32 v231, v142, v143
    v_cvt_pk_bf16_f32 v239, v150, v151
    v_xor_b32 v247, 0x80008000, v239
    v_add_f32 v131, 0x41800000, v129
    v_mul_f32 v131, 0x3d000000, v131
    v_add_f32 v132, 0x0, v130
    v_mul_f32 v132, v132, v131
    v_cos_f32 v136, v132
    v_sin_f32 v144, v132
    v_add_f32 v132, 0x40800000, v130
    v_mul_f32 v132, v132, v131
    v_cos_f32 v137, v132
    v_sin_f32 v145, v132
    v_add_f32 v132, 0x41000000, v130
    v_mul_f32 v132, v132, v131
    v_cos_f32 v138, v132
    v_sin_f32 v146, v132
    v_add_f32 v132, 0x41400000, v130
    v_mul_f32 v132, v132, v131
    v_cos_f32 v139, v132
    v_sin_f32 v147, v132
    v_add_f32 v132, 0x41800000, v130
    v_mul_f32 v132, v132, v131
    v_cos_f32 v140, v132
    v_sin_f32 v148, v132
    v_add_f32 v132, 0x41a00000, v130
    v_mul_f32 v132, v132, v131
    v_cos_f32 v141, v132
    v_sin_f32 v149, v132
    v_add_f32 v132, 0x41c00000, v130
    v_mul_f32 v132, v132, v131
    v_cos_f32 v142, v132
    v_sin_f32 v150, v132
    v_add_f32 v132, 0x41e00000, v130
    v_mul_f32 v132, v132, v131
    v_cos_f32 v143, v132
    v_sin_f32 v151, v132
    v_cvt_pk_bf16_f32 v232, v136, v137
    v_cvt_pk_bf16_f32 v240, v144, v145
    v_xor_b32 v248, 0x80008000, v240
    v_cvt_pk_bf16_f32 v233, v138, v139
    v_cvt_pk_bf16_f32 v241, v146, v147
    v_xor_b32 v249, 0x80008000, v241
    v_cvt_pk_bf16_f32 v234, v140, v141
    v_cvt_pk_bf16_f32 v242, v148, v149
    v_xor_b32 v250, 0x80008000, v242
    v_cvt_pk_bf16_f32 v235, v142, v143
    v_cvt_pk_bf16_f32 v243, v150, v151
    v_xor_b32 v251, 0x80008000, v243
    s_bitcmp1_b32 s93, 0
    s_cselect_b32 s80, 24576, s80
    s_cselect_b32 s81, 32768, s81
    s_cselect_b32 s82, 40960, s82
    s_cselect_b32 s83, 49152, s83
    s_cselect_b32 s84, 0, s84
    s_cselect_b32 s85, 8192, s85
    s_cselect_b32 s86, 16384, s86
    s_sub_u32 s62, s58, 14
    s_lshl1_add_u32 s62, s57, s62
    s_lshl_b32 s63, s56, 5
    s_add_u32 s62, s62, s63
    s_lshl_b32 s62, s62, 7
    s_add_u32 s90, s62, 10485760
L_j0_41:
    v_mov_b64 v[0:1], 0
    v_mov_b64 v[2:3], 0
    v_mov_b64 v[4:5], 0
    v_mov_b64 v[6:7], 0
    v_mov_b64 v[8:9], 0
    v_mov_b64 v[10:11], 0
    v_mov_b64 v[12:13], 0
    v_mov_b64 v[14:15], 0
    v_mov_b64 v[16:17], 0
    v_mov_b64 v[18:19], 0
    v_mov_b64 v[20:21], 0
    v_mov_b64 v[22:23], 0
    v_mov_b64 v[24:25], 0
    v_mov_b64 v[26:27], 0
    v_mov_b64 v[28:29], 0
    v_mov_b64 v[30:31], 0
    v_mov_b64 v[32:33], 0
    v_mov_b64 v[34:35], 0
    v_mov_b64 v[36:37], 0
    v_mov_b64 v[38:39], 0
    v_mov_b64 v[40:41], 0
    v_mov_b64 v[42:43], 0
    v_mov_b64 v[44:45], 0
    v_mov_b64 v[46:47], 0
    v_mov_b64 v[48:49], 0
    v_mov_b64 v[50:51], 0
    v_mov_b64 v[52:53], 0
    v_mov_b64 v[54:55], 0
    v_mov_b64 v[56:57], 0
    v_mov_b64 v[58:59], 0
    v_mov_b64 v[60:61], 0
    v_mov_b64 v[62:63], 0
    v_mov_b64 v[64:65], 0
    v_mov_b64 v[66:67], 0
    v_mov_b64 v[68:69], 0
    v_mov_b64 v[70:71], 0
    v_mov_b64 v[72:73], 0
    v_mov_b64 v[74:75], 0
    v_mov_b64 v[76:77], 0
    v_mov_b64 v[78:79], 0
    v_mov_b64 v[80:81], 0
    v_mov_b64 v[82:83], 0
    v_mov_b64 v[84:85], 0
    v_mov_b64 v[86:87], 0
    v_mov_b64 v[88:89], 0
    v_mov_b64 v[90:91], 0
    v_mov_b64 v[92:93], 0
    v_mov_b64 v[94:95], 0
    v_mov_b64 v[96:97], 0
    v_mov_b64 v[98:99], 0
    v_mov_b64 v[100:101], 0
    v_mov_b64 v[102:103], 0
    v_mov_b64 v[104:105], 0
    v_mov_b64 v[106:107], 0
    v_mov_b64 v[108:109], 0
    v_mov_b64 v[110:111], 0
    v_mov_b64 v[112:113], 0
    v_mov_b64 v[114:115], 0
    v_mov_b64 v[116:117], 0
    v_mov_b64 v[118:119], 0
    v_mov_b64 v[120:121], 0
    v_mov_b64 v[122:123], 0
    v_mov_b64 v[124:125], 0
    v_mov_b64 v[126:127], 0
    s_cmp_eq_u32 s87, 1
    s_cbranch_scc1 L_c1_11
    s_cmp_eq_u32 s87, 0
    s_cbranch_scc1 L_c0_10
    s_waitcnt vmcnt(0)
    s_branch L_rj_7
L_c0_10:
    v_and_b32 v140, 15, v255
    v_and_b32 v141, 1, v140
    v_lshlrev_b32 v141, 4, v141
    v_mov_b32 v142, 0x3f80
    v_lshlrev_b32 v141, v141, v142
    v_lshrrev_b32 v140, 1, v140
    v_cmp_eq_u32 vcc, 0, v140
    s_nop 1
    v_cndmask_b32 v132, 0, v141, vcc
    v_cmp_eq_u32 vcc, 1, v140
    s_nop 1
    v_cndmask_b32 v133, 0, v141, vcc
    v_cmp_eq_u32 vcc, 2, v140
    s_nop 1
    v_cndmask_b32 v134, 0, v141, vcc
    v_cmp_eq_u32 vcc, 3, v140
    s_nop 1
    v_cndmask_b32 v135, 0, v141, vcc
    v_and_b32 v140, 7, v255
    v_lshlrev_b32 v140, 5, v140
    v_and_b32 v141, 16, v255
    v_add3_u32 v140, v140, v141, s68
    v_and_b32 v141, 0x28, v255
    v_cmp_eq_u32 vcc, 0, v141
    s_nop 1
    v_cndmask_b32 v253, v253, v140, vcc
    v_mov_b32 v140, 0x07060500
    v_mov_b32 v141, 0x07060501
    v_mov_b32 v142, 0x07060502
    v_mov_b32 v143, 0x07060503
    s_waitcnt vmcnt(16)
    v_readfirstlane_b32 s6, v128
    s_nop 0
    s_mul_i32 s6, s6, 0x9e3779b1
    s_add_u32 s6, s6, 0x7f4a7c15
    s_not_b32 s7, s6
    s_waitcnt vmcnt(15)
    v_mfma_f32_16x16x32_bf16 v[136:139], v[132:135], v[160:163], 0
    s_waitcnt vmcnt(14)
    v_mfma_f32_16x16x32_bf16 v[136:139], v[132:135], v[164:167], v[136:139]
    s_waitcnt vmcnt(13)
    v_mfma_f32_16x16x32_bf16 v[136:139], v[132:135], v[168:171], v[136:139]
    s_waitcnt vmcnt(12)
    v_mfma_f32_16x16x32_bf16 v[136:139], v[132:135], v[172:175], v[136:139]
    s_waitcnt vmcnt(11)
    v_mfma_f32_16x16x32_bf16 v[136:139], v[132:135], v[176:179], v[136:139]
    s_waitcnt vmcnt(10)
    v_mfma_f32_16x16x32_bf16 v[136:139], v[132:135], v[180:183], v[136:139]
    s_waitcnt vmcnt(9)
    v_mfma_f32_16x16x32_bf16 v[136:139], v[132:135], v[184:187], v[136:139]
    s_waitcnt vmcnt(8)
    v_mfma_f32_16x16x32_bf16 v[136:139], v[132:135], v[188:191], v[136:139]
    s_waitcnt vmcnt(7)
    v_mfma_f32_16x16x32_bf16 v[136:139], v[132:135], v[192:195], v[136:139]
    s_waitcnt vmcnt(6)
    v_mfma_f32_16x16x32_bf16 v[136:139], v[132:135], v[196:199], v[136:139]
    s_waitcnt vmcnt(5)
    v_mfma_f32_16x16x32_bf16 v[136:139], v[132:135], v[200:203], v[136:139]
    s_waitcnt vmcnt(4)
    v_mfma_f32_16x16x32_bf16 v[136:139], v[132:135], v[204:207], v[136:139]
    s_waitcnt vmcnt(3)
    v_mfma_f32_16x16x32_bf16 v[136:139], v[132:135], v[208:211], v[136:139]
    s_waitcnt vmcnt(2)
    v_mfma_f32_16x16x32_bf16 v[136:139], v[132:135], v[212:215], v[136:139]
    s_waitcnt vmcnt(1)
    v_mfma_f32_16x16x32_bf16 v[136:139], v[132:135], v[216:219], v[136:139]
    s_waitcnt vmcnt(0)
    v_mfma_f32_16x16x32_bf16 v[136:139], v[132:135], v[220:223], v[136:139]
    s_nop 7
    s_nop 1
    v_add_f32_dpp v160, v136, v136 row_ror:8 row_mask:0xf bank_mask:0xf
    v_add_f32_dpp v161, v137, v137 row_ror:8 row_mask:0xf bank_mask:0xf
    v_add_f32_dpp v162, v138, v138 row_ror:8 row_mask:0xf bank_mask:0xf
    v_add_f32_dpp v163, v139, v139 row_ror:8 row_mask:0xf bank_mask:0xf
    v_perm_b32 v160, v160, s6, v140
    v_perm_b32 v161, v161, s6, v141
    v_perm_b32 v162, v162, s6, v142
    v_perm_b32 v163, v163, s6, v143
    s_branch L_rj_7
L_c1_11:
    v_and_b32 v141, 15, v255
    v_cmp_eq_u32 vcc, 0, v141
    v_lshl_add_u32 v140, v255, 1, s68
    v_mov_b32 v131, 0x3f803f80
    v_cndmask_b32 v253, v253, v140, vcc
    v_mov_b32 v132, 0
    v_mov_b32 v133, 0
    v_mov_b32 v134, 0x00003f80
    v_mov_b32 v135, 0x3f800000
    v_mov_b32 v136, 0
    v_mov_b32 v137, 0
    s_waitcnt vmcnt(4)
    v_readfirstlane_b32 s6, v128
    s_nop 0
    s_mul_i32 s6, s6, 0x9e3779b1
    s_add_u32 s6, s6, 0x7f4a7c15
    s_not_b32 s7, s6
    s_waitcnt vmcnt(3)
    v_dot2c_f32_bf16 v132, v168, v131
    v_dot2c_f32_bf16 v133, v169, v131
    v_dot2c_f32_bf16 v132, v170, v131
    v_dot2c_f32_bf16 v133, v171, v131
    s_waitcnt vmcnt(2)
    v_dot2c_f32_bf16 v132, v172, v131
    v_dot2c_f32_bf16 v133, v173, v131
    v_dot2c_f32_bf16 v132, v174, v131
    v_dot2c_f32_bf16 v133, v175, v131
    s_waitcnt vmcnt(1)
    v_dot2c_f32_bf16 v132, v176, v131
    v_dot2c_f32_bf16 v133, v177, v131
    v_dot2c_f32_bf16 v132, v178, v131
    v_dot2c_f32_bf16 v133, v179, v131
    s_waitcnt vmcnt(0)
    v_dot2c_f32_bf16 v132, v180, v131
    v_dot2c_f32_bf16 v133, v181, v131
    v_dot2c_f32_bf16 v132, v182, v131
    v_dot2c_f32_bf16 v133, v183, v131
    s_nop 2
    v_add_f32 v132, v132, v133
    s_nop 1
    v_add_f32_dpp v132, v132, v132 row_ror:8 row_mask:0xf bank_mask:0xf
    s_nop 1
    v_add_f32_dpp v132, v132, v132 row_ror:4 row_mask:0xf bank_mask:0xf
    s_nop 1
    v_add_f32_dpp v132, v132, v132 row_ror:2 row_mask:0xf bank_mask:0xf
    s_nop 1
    v_add_f32_dpp v132, v132, v132 row_ror:1 row_mask:0xf bank_mask:0xf
    v_mul_f32 v132, 0xbb000000, v132
    v_dot2_f32_bf16 v144, v168, v134, v132
    v_dot2_f32_bf16 v145, v168, v135, v132
    v_dot2_f32_bf16 v146, v169, v134, v132
    v_dot2_f32_bf16 v147, v169, v135, v132
    v_dot2_f32_bf16 v148, v170, v134, v132
    v_dot2_f32_bf16 v149, v170, v135, v132
    v_dot2_f32_bf16 v150, v171, v134, v132
    v_dot2_f32_bf16 v151, v171, v135, v132
    v_fmac_f32 v136, v144, v144
    v_fmac_f32 v137, v145, v145
    v_fmac_f32 v136, v146, v146
    v_fmac_f32 v137, v147, v147
    v_fmac_f32 v136, v148, v148
    v_fmac_f32 v137, v149, v149
    v_fmac_f32 v136, v150, v150
    v_fmac_f32 v137, v151, v151
    v_dot2_f32_bf16 v144, v172, v134, v132
    v_dot2_f32_bf16 v145, v172, v135, v132
    v_dot2_f32_bf16 v146, v173, v134, v132
    v_dot2_f32_bf16 v147, v173, v135, v132
    v_dot2_f32_bf16 v148, v174, v134, v132
    v_dot2_f32_bf16 v149, v174, v135, v132
    v_dot2_f32_bf16 v150, v175, v134, v132
    v_dot2_f32_bf16 v151, v175, v135, v132
    v_fmac_f32 v136, v144, v144
    v_fmac_f32 v137, v145, v145
    v_fmac_f32 v136, v146, v146
    v_fmac_f32 v137, v147, v147
    v_fmac_f32 v136, v148, v148
    v_fmac_f32 v137, v149, v149
    v_fmac_f32 v136, v150, v150
    v_fmac_f32 v137, v151, v151
    v_dot2_f32_bf16 v144, v176, v134, v132
    v_dot2_f32_bf16 v145, v176, v135, v132
    v_dot2_f32_bf16 v146, v177, v134, v132
    v_dot2_f32_bf16 v147, v177, v135, v132
    v_dot2_f32_bf16 v148, v178, v134, v132
    v_dot2_f32_bf16 v149, v178, v135, v132
    v_dot2_f32_bf16 v150, v179, v134, v132
    v_dot2_f32_bf16 v151, v179, v135, v132
    v_fmac_f32 v136, v144, v144
    v_fmac_f32 v137, v145, v145
    v_fmac_f32 v136, v146, v146
    v_fmac_f32 v137, v147, v147
    v_fmac_f32 v136, v148, v148
    v_fmac_f32 v137, v149, v149
    v_fmac_f32 v136, v150, v150
    v_fmac_f32 v137, v151, v151
    v_dot2_f32_bf16 v144, v180, v134, v132
    v_dot2_f32_bf16 v145, v180, v135, v132
    v_dot2_f32_bf16 v146, v181, v134, v132
    v_dot2_f32_bf16 v147, v181, v135, v132
    v_dot2_f32_bf16 v148, v182, v134, v132
    v_dot2_f32_bf16 v149, v182, v135, v132
    v_dot2_f32_bf16 v150, v183, v134, v132
    v_dot2_f32_bf16 v151, v183, v135, v132
    v_fmac_f32 v136, v144, v144
    v_fmac_f32 v137, v145, v145
    v_fmac_f32 v136, v146, v146
    v_fmac_f32 v137, v147, v147
    v_fmac_f32 v136, v148, v148
    v_fmac_f32 v137, v149, v149
    v_fmac_f32 v136, v150, v150
    v_fmac_f32 v137, v151, v151
    v_add_f32 v136, v136, v137
    s_nop 1
    v_add_f32_dpp v136, v136, v136 row_ror:8 row_mask:0xf bank_mask:0xf
    s_nop 1
    v_add_f32_dpp v136, v136, v136 row_ror:4 row_mask:0xf bank_mask:0xf
    s_nop 1
    v_add_f32_dpp v136, v136, v136 row_ror:2 row_mask:0xf bank_mask:0xf
    s_nop 1
    v_add_f32_dpp v136, v136, v136 row_ror:1 row_mask:0xf bank_mask:0xf
    v_mul_f32 v136, 0x3b000000, v136
    v_cvt_pk_bf16_f32 v136, v136, v132
    v_and_b32 v160, 0xffff0000, v136
    v_lshlrev_b32 v136, 16, v136
    v_add_f32 v136, 0x3727c5ac, v136
    v_cvt_pk_bf16_f32 v136, v136, v136
    v_lshlrev_b32 v136, 16, v136
    v_sqrt_f32 v136, v136
    s_nop 0
    v_cvt_pk_bf16_f32 v136, v136, v136
    v_lshlrev_b32 v136, 16, v136
    v_rcp_f32 v163, v136
    v_mul_f32 v162, v136, v136
    v_sub_f32 v136, v160, v132
    v_mul_f32 v136, 0x44000000, v136
    v_mul_f32 v136, v136, v163
    v_cvt_pk_bf16_f32 v160, v136, v160
    v_mov_b32 v161, s6
    buffer_store_dwordx4 v[160:163], v253, s[20:23], 0 offen sc1
    v_mov_b32 v253, 1073741824
L_rj_7:
    s_cmp_ge_u32 s58, 14
    s_cbranch_scc1 L_sp_3
    s_mov_b32 s70, 0
    s_mov_b32 s72, 6
    s_barrier
    ds_read_b64_tr_b16 v[192:193], v226 offset:16384
    ds_read_b64_tr_b16 v[194:195], v226 offset:17408
    ds_read_b64_tr_b16 v[196:197], v227 offset:16384
    ds_read_b64_tr_b16 v[198:199], v227 offset:17408
    ds_read_b64_tr_b16 v[200:201], v226 offset:32768
    ds_read_b64_tr_b16 v[202:203], v226 offset:33792
    ds_read_b64_tr_b16 v[204:205], v227 offset:32768
    ds_read_b64_tr_b16 v[206:207], v227 offset:33792
    ds_read_b128 v[128:131], v224 offset:0
    ds_read_b128 v[132:135], v224 offset:2048
    ds_read_b128 v[136:139], v224 offset:4096
    ds_read_b128 v[140:143], v224 offset:6144
    ds_read_b128 v[144:147], v224 offset:8192
    ds_read_b128 v[148:151], v224 offset:10240
    ds_read_b128 v[152:155], v224 offset:12288
    ds_read_b128 v[156:159], v224 offset:14336
    buffer_store_dwordx4 v[160:163], v253, s[20:23], 0 offen sc1
L_loop_42:
    s_waitcnt lgkmcnt(0)
    v_mfma_f32_16x16x32_bf16 v[0:3], v[192:195], v[128:131], v[0:3]
    ds_read_b64_tr_b16 v[208:209], v226 offset:24576
    v_mfma_f32_16x16x32_bf16 v[4:7], v[196:199], v[128:131], v[4:7]
    ds_read_b64_tr_b16 v[210:211], v226 offset:25600
    v_mfma_f32_16x16x32_bf16 v[8:11], v[200:203], v[128:131], v[8:11]
    ds_read_b64_tr_b16 v[212:213], v227 offset:24576
    v_mfma_f32_16x16x32_bf16 v[12:15], v[204:207], v[128:131], v[12:15]
    ds_read_b64_tr_b16 v[214:215], v227 offset:25600
    v_mfma_f32_16x16x32_bf16 v[28:31], v[204:207], v[132:135], v[28:31]
    ds_read_b64_tr_b16 v[216:217], v226 offset:40960
    v_mfma_f32_16x16x32_bf16 v[24:27], v[200:203], v[132:135], v[24:27]
    ds_read_b64_tr_b16 v[218:219], v226 offset:41984
    v_mfma_f32_16x16x32_bf16 v[20:23], v[196:199], v[132:135], v[20:23]
    ds_read_b64_tr_b16 v[220:221], v227 offset:40960
    v_mfma_f32_16x16x32_bf16 v[16:19], v[192:195], v[132:135], v[16:19]
    ds_read_b64_tr_b16 v[222:223], v227 offset:41984
    v_mfma_f32_16x16x32_bf16 v[32:35], v[192:195], v[136:139], v[32:35]
    ds_read_b128 v[160:163], v225 offset:0
    v_mfma_f32_16x16x32_bf16 v[36:39], v[196:199], v[136:139], v[36:39]
    ds_read_b128 v[164:167], v225 offset:2048
    v_mfma_f32_16x16x32_bf16 v[40:43], v[200:203], v[136:139], v[40:43]
    ds_read_b128 v[168:171], v225 offset:4096
    v_mfma_f32_16x16x32_bf16 v[44:47], v[204:207], v[136:139], v[44:47]
    ds_read_b128 v[172:175], v225 offset:6144
    v_mfma_f32_16x16x32_bf16 v[60:63], v[204:207], v[140:143], v[60:63]
    ds_read_b128 v[176:179], v225 offset:8192
    v_mfma_f32_16x16x32_bf16 v[56:59], v[200:203], v[140:143], v[56:59]
    ds_read_b128 v[180:183], v225 offset:10240
    v_mfma_f32_16x16x32_bf16 v[52:55], v[196:199], v[140:143], v[52:55]
    ds_read_b128 v[184:187], v225 offset:12288
    v_mfma_f32_16x16x32_bf16 v[48:51], v[192:195], v[140:143], v[48:51]
    ds_read_b128 v[188:191], v225 offset:14336
    v_mfma_f32_16x16x32_bf16 v[64:67], v[192:195], v[144:147], v[64:67]
    s_add_u32 s70, s70, 1
    s_cmp_eq_u32 s70, 3
    v_mfma_f32_16x16x32_bf16 v[68:71], v[196:199], v[144:147], v[68:71]
    s_cselect_b32 s71, -98304, s73
    s_cselect_b32 s70, 0, s70
    v_mfma_f32_16x16x32_bf16 v[72:75], v[200:203], v[144:147], v[72:75]
    v_add_u32 v224, s71, v224
    v_mfma_f32_16x16x32_bf16 v[76:79], v[204:207], v[144:147], v[76:79]
    v_add_u32 v225, s71, v225
    v_mfma_f32_16x16x32_bf16 v[92:95], v[204:207], v[148:151], v[92:95]
    v_add_u32 v226, s71, v226
    v_mfma_f32_16x16x32_bf16 v[88:91], v[200:203], v[148:151], v[88:91]
    v_add_u32 v227, s71, v227
    v_mfma_f32_16x16x32_bf16 v[84:87], v[196:199], v[148:151], v[84:87]
    v_mfma_f32_16x16x32_bf16 v[80:83], v[192:195], v[148:151], v[80:83]
    v_mfma_f32_16x16x32_bf16 v[96:99], v[192:195], v[152:155], v[96:99]
    v_mfma_f32_16x16x32_bf16 v[100:103], v[196:199], v[152:155], v[100:103]
    v_mfma_f32_16x16x32_bf16 v[104:107], v[200:203], v[152:155], v[104:107]
    v_mfma_f32_16x16x32_bf16 v[108:111], v[204:207], v[152:155], v[108:111]
    v_mfma_f32_16x16x32_bf16 v[124:127], v[204:207], v[156:159], v[124:127]
    v_mfma_f32_16x16x32_bf16 v[120:123], v[200:203], v[156:159], v[120:123]
    v_mfma_f32_16x16x32_bf16 v[116:119], v[196:199], v[156:159], v[116:119]
    v_mfma_f32_16x16x32_bf16 v[112:115], v[192:195], v[156:159], v[112:115]
    s_waitcnt lgkmcnt(0)
    s_barrier
    v_mfma_f32_16x16x32_bf16 v[0:3], v[208:211], v[160:163], v[0:3]
    ds_read_b64_tr_b16 v[192:193], v226 offset:16384
    v_mfma_f32_16x16x32_bf16 v[4:7], v[212:215], v[160:163], v[4:7]
    ds_read_b64_tr_b16 v[194:195], v226 offset:17408
    v_mfma_f32_16x16x32_bf16 v[8:11], v[216:219], v[160:163], v[8:11]
    ds_read_b64_tr_b16 v[196:197], v227 offset:16384
    v_mfma_f32_16x16x32_bf16 v[12:15], v[220:223], v[160:163], v[12:15]
    ds_read_b64_tr_b16 v[198:199], v227 offset:17408
    v_mfma_f32_16x16x32_bf16 v[28:31], v[220:223], v[164:167], v[28:31]
    ds_read_b64_tr_b16 v[200:201], v226 offset:32768
    v_mfma_f32_16x16x32_bf16 v[24:27], v[216:219], v[164:167], v[24:27]
    ds_read_b64_tr_b16 v[202:203], v226 offset:33792
    v_mfma_f32_16x16x32_bf16 v[20:23], v[212:215], v[164:167], v[20:23]
    ds_read_b64_tr_b16 v[204:205], v227 offset:32768
    v_mfma_f32_16x16x32_bf16 v[16:19], v[208:211], v[164:167], v[16:19]
    ds_read_b64_tr_b16 v[206:207], v227 offset:33792
    v_mfma_f32_16x16x32_bf16 v[32:35], v[208:211], v[168:171], v[32:35]
    ds_read_b128 v[128:131], v224 offset:0
    v_mfma_f32_16x16x32_bf16 v[36:39], v[212:215], v[168:171], v[36:39]
    ds_read_b128 v[132:135], v224 offset:2048
    v_mfma_f32_16x16x32_bf16 v[40:43], v[216:219], v[168:171], v[40:43]
    ds_read_b128 v[136:139], v224 offset:4096
    v_mfma_f32_16x16x32_bf16 v[44:47], v[220:223], v[168:171], v[44:47]
    ds_read_b128 v[140:143], v224 offset:6144
    v_mfma_f32_16x16x32_bf16 v[60:63], v[220:223], v[172:175], v[60:63]
    ds_read_b128 v[144:147], v224 offset:8192
    v_mfma_f32_16x16x32_bf16 v[56:59], v[216:219], v[172:175], v[56:59]
    ds_read_b128 v[148:151], v224 offset:10240
    v_mfma_f32_16x16x32_bf16 v[52:55], v[212:215], v[172:175], v[52:55]
    ds_read_b128 v[152:155], v224 offset:12288
    v_mfma_f32_16x16x32_bf16 v[48:51], v[208:211], v[172:175], v[48:51]
    ds_read_b128 v[156:159], v224 offset:14336
    v_mfma_f32_16x16x32_bf16 v[64:67], v[208:211], v[176:179], v[64:67]
    s_sub_u32 s72, s72, 1
    s_cmp_lg_u32 s72, 0
    v_mfma_f32_16x16x32_bf16 v[68:71], v[212:215], v[176:179], v[68:71]
    v_mfma_f32_16x16x32_bf16 v[72:75], v[216:219], v[176:179], v[72:75]
    v_mfma_f32_16x16x32_bf16 v[76:79], v[220:223], v[176:179], v[76:79]
    v_mfma_f32_16x16x32_bf16 v[92:95], v[220:223], v[180:183], v[92:95]
    v_mfma_f32_16x16x32_bf16 v[88:91], v[216:219], v[180:183], v[88:91]
    v_mfma_f32_16x16x32_bf16 v[84:87], v[212:215], v[180:183], v[84:87]
    v_mfma_f32_16x16x32_bf16 v[80:83], v[208:211], v[180:183], v[80:83]
    v_mfma_f32_16x16x32_bf16 v[96:99], v[208:211], v[184:187], v[96:99]
    v_mfma_f32_16x16x32_bf16 v[100:103], v[212:215], v[184:187], v[100:103]
    v_mfma_f32_16x16x32_bf16 v[104:107], v[216:219], v[184:187], v[104:107]
    v_mfma_f32_16x16x32_bf16 v[108:111], v[220:223], v[184:187], v[108:111]
    v_mfma_f32_16x16x32_bf16 v[124:127], v[220:223], v[188:191], v[124:127]
    v_mfma_f32_16x16x32_bf16 v[120:123], v[216:219], v[188:191], v[120:123]
    v_mfma_f32_16x16x32_bf16 v[116:119], v[212:215], v[188:191], v[116:119]
    v_mfma_f32_16x16x32_bf16 v[112:115], v[208:211], v[188:191], v[112:115]
    s_cbranch_scc1 L_loop_42
    s_waitcnt lgkmcnt(0)
    v_mfma_f32_16x16x32_bf16 v[0:3], v[192:195], v[128:131], v[0:3]
    ds_read_b64_tr_b16 v[208:209], v226 offset:24576
    ds_read_b64_tr_b16 v[210:211], v226 offset:25600
    v_mfma_f32_16x16x32_bf16 v[4:7], v[196:199], v[128:131], v[4:7]
    ds_read_b64_tr_b16 v[212:213], v227 offset:24576
    ds_read_b64_tr_b16 v[214:215], v227 offset:25600
    v_mfma_f32_16x16x32_bf16 v[8:11], v[200:203], v[128:131], v[8:11]
    ds_read_b64_tr_b16 v[216:217], v226 offset:40960
    ds_read_b64_tr_b16 v[218:219], v226 offset:41984
    v_mfma_f32_16x16x32_bf16 v[12:15], v[204:207], v[128:131], v[12:15]
    ds_read_b64_tr_b16 v[220:221], v227 offset:40960
    ds_read_b64_tr_b16 v[222:223], v227 offset:41984
    v_mfma_f32_16x16x32_bf16 v[28:31], v[204:207], v[132:135], v[28:31]
    ds_read_b128 v[160:163], v225 offset:0
    ds_read_b128 v[164:167], v225 offset:2048
    v_mfma_f32_16x16x32_bf16 v[24:27], v[200:203], v[132:135], v[24:27]
    ds_read_b128 v[168:171], v225 offset:4096
    ds_read_b128 v[172:175], v225 offset:6144
    v_mfma_f32_16x16x32_bf16 v[20:23], v[196:199], v[132:135], v[20:23]
    v_add_u32 v224, 49152, v224
    v_add_u32 v225, 49152, v225
    v_mfma_f32_16x16x32_bf16 v[16:19], v[192:195], v[132:135], v[16:19]
    v_add_u32 v226, 49152, v226
    v_add_u32 v227, 49152, v227
    v_mfma_f32_16x16x32_bf16 v[32:35], v[192:195], v[136:139], v[32:35]
    v_mfma_f32_16x16x32_bf16 v[36:39], v[196:199], v[136:139], v[36:39]
    v_mfma_f32_16x16x32_bf16 v[40:43], v[200:203], v[136:139], v[40:43]
    v_mfma_f32_16x16x32_bf16 v[44:47], v[204:207], v[136:139], v[44:47]
    v_mfma_f32_16x16x32_bf16 v[60:63], v[204:207], v[140:143], v[60:63]
    v_mfma_f32_16x16x32_bf16 v[56:59], v[200:203], v[140:143], v[56:59]
    v_mfma_f32_16x16x32_bf16 v[52:55], v[196:199], v[140:143], v[52:55]
    v_mfma_f32_16x16x32_bf16 v[48:51], v[192:195], v[140:143], v[48:51]
    s_waitcnt lgkmcnt(0)
    s_barrier
    v_mfma_f32_16x16x32_bf16 v[0:3], v[208:211], v[160:163], v[0:3]
    ds_read_b64_tr_b16 v[192:193], v226 offset:16384
    ds_read_b64_tr_b16 v[194:195], v226 offset:17408
    v_mfma_f32_16x16x32_bf16 v[4:7], v[212:215], v[160:163], v[4:7]
    ds_read_b64_tr_b16 v[196:197], v227 offset:16384
    ds_read_b64_tr_b16 v[198:199], v227 offset:17408
    v_mfma_f32_16x16x32_bf16 v[8:11], v[216:219], v[160:163], v[8:11]
    ds_read_b64_tr_b16 v[200:201], v226 offset:32768
    ds_read_b64_tr_b16 v[202:203], v226 offset:33792
    v_mfma_f32_16x16x32_bf16 v[12:15], v[220:223], v[160:163], v[12:15]
    ds_read_b64_tr_b16 v[204:205], v227 offset:32768
    ds_read_b64_tr_b16 v[206:207], v227 offset:33792
    v_mfma_f32_16x16x32_bf16 v[28:31], v[220:223], v[164:167], v[28:31]
    ds_read_b128 v[128:131], v224 offset:0
    ds_read_b128 v[132:135], v224 offset:2048
    v_mfma_f32_16x16x32_bf16 v[24:27], v[216:219], v[164:167], v[24:27]
    ds_read_b128 v[136:139], v224 offset:4096
    ds_read_b128 v[140:143], v224 offset:6144
    v_mfma_f32_16x16x32_bf16 v[20:23], v[212:215], v[164:167], v[20:23]
    v_mfma_f32_16x16x32_bf16 v[16:19], v[208:211], v[164:167], v[16:19]
    v_mfma_f32_16x16x32_bf16 v[32:35], v[208:211], v[168:171], v[32:35]
    v_mfma_f32_16x16x32_bf16 v[36:39], v[212:215], v[168:171], v[36:39]
    v_mfma_f32_16x16x32_bf16 v[40:43], v[216:219], v[168:171], v[40:43]
    v_mfma_f32_16x16x32_bf16 v[44:47], v[220:223], v[168:171], v[44:47]
    v_mfma_f32_16x16x32_bf16 v[60:63], v[220:223], v[172:175], v[60:63]
    v_mfma_f32_16x16x32_bf16 v[56:59], v[216:219], v[172:175], v[56:59]
    v_mfma_f32_16x16x32_bf16 v[52:55], v[212:215], v[172:175], v[52:55]
    v_mfma_f32_16x16x32_bf16 v[48:51], v[208:211], v[172:175], v[48:51]
    s_waitcnt lgkmcnt(0)
    v_mfma_f32_16x16x32_bf16 v[0:3], v[192:195], v[128:131], v[0:3]
    ds_read_b64_tr_b16 v[208:209], v226 offset:24576
    ds_read_b64_tr_b16 v[210:211], v226 offset:25600
    v_mfma_f32_16x16x32_bf16 v[4:7], v[196:199], v[128:131], v[4:7]
    ds_read_b64_tr_b16 v[212:213], v227 offset:24576
    ds_read_b64_tr_b16 v[214:215], v227 offset:25600
    v_mfma_f32_16x16x32_bf16 v[8:11], v[200:203], v[128:131], v[8:11]
    ds_read_b64_tr_b16 v[216:217], v226 offset:40960
    ds_read_b64_tr_b16 v[218:219], v226 offset:41984
    v_mfma_f32_16x16x32_bf16 v[12:15], v[204:207], v[128:131], v[12:15]
    ds_read_b64_tr_b16 v[220:221], v227 offset:40960
    ds_read_b64_tr_b16 v[222:223], v227 offset:41984
    v_mfma_f32_16x16x32_bf16 v[28:31], v[204:207], v[132:135], v[28:31]
    ds_read_b128 v[160:163], v225 offset:0
    ds_read_b128 v[164:167], v225 offset:2048
    v_mfma_f32_16x16x32_bf16 v[24:27], v[200:203], v[132:135], v[24:27]
    ds_read_b128 v[168:171], v225 offset:4096
    ds_read_b128 v[172:175], v225 offset:6144
    v_mfma_f32_16x16x32_bf16 v[20:23], v[196:199], v[132:135], v[20:23]
    ds_read_b32 v231, v228 offset:0
    ds_read_b32 v249, v228 offset:1024
    v_mfma_f32_16x16x32_bf16 v[16:19], v[192:195], v[132:135], v[16:19]
    ds_read_b32 v250, v228 offset:2048
    ds_read_b32 v251, v228 offset:3072
    v_mfma_f32_16x16x32_bf16 v[32:35], v[192:195], v[136:139], v[32:35]
    ds_read_b128 v[144:147], v229 offset:0
    ds_read_b128 v[148:151], v229 offset:256
    v_mfma_f32_16x16x32_bf16 v[36:39], v[196:199], v[136:139], v[36:39]
    ds_read_b128 v[152:155], v229 offset:512
    ds_read_b128 v[156:159], v229 offset:768
    v_mfma_f32_16x16x32_bf16 v[40:43], v[200:203], v[136:139], v[40:43]
    v_mfma_f32_16x16x32_bf16 v[44:47], v[204:207], v[136:139], v[44:47]
    v_mfma_f32_16x16x32_bf16 v[60:63], v[204:207], v[140:143], v[60:63]
    v_mfma_f32_16x16x32_bf16 v[56:59], v[200:203], v[140:143], v[56:59]
    v_mfma_f32_16x16x32_bf16 v[52:55], v[196:199], v[140:143], v[52:55]
    v_mfma_f32_16x16x32_bf16 v[48:51], v[192:195], v[140:143], v[48:51]
    s_waitcnt lgkmcnt(0)
    v_mfma_f32_16x16x32_bf16 v[0:3], v[208:211], v[160:163], v[0:3]
    v_and_b32 v231, 0xffffff00, v231
    v_and_b32 v249, 0xffffff00, v249
    v_mfma_f32_16x16x32_bf16 v[4:7], v[212:215], v[160:163], v[4:7]
    v_and_b32 v250, 0xffffff00, v250
    v_and_b32 v251, 0xffffff00, v251
    v_mfma_f32_16x16x32_bf16 v[8:11], v[216:219], v[160:163], v[8:11]
    v_add_f32 v231, v231, v249
    v_add_f32 v250, v250, v251
    v_mfma_f32_16x16x32_bf16 v[12:15], v[220:223], v[160:163], v[12:15]
    v_add_f32 v231, v231, v250
    v_and_b32 v144, 0xffff0000, v144
    v_mfma_f32_16x16x32_bf16 v[28:31], v[220:223], v[164:167], v[28:31]
    v_and_b32 v148, 0xffff0000, v148
    v_and_b32 v152, 0xffff0000, v152
    v_mfma_f32_16x16x32_bf16 v[24:27], v[216:219], v[164:167], v[24:27]
    v_and_b32 v156, 0xffff0000, v156
    ds_read_b128 v[128:131], v224 offset:8192
    v_mfma_f32_16x16x32_bf16 v[20:23], v[212:215], v[164:167], v[20:23]
    ds_read_b128 v[132:135], v224 offset:10240
    ds_read_b128 v[136:139], v224 offset:12288
    v_mfma_f32_16x16x32_bf16 v[16:19], v[208:211], v[164:167], v[16:19]
    ds_read_b128 v[140:143], v224 offset:14336
    ds_read_b128 v[232:235], v225 offset:8192
    v_mfma_f32_16x16x32_bf16 v[32:35], v[208:211], v[168:171], v[32:35]
    ds_read_b128 v[236:239], v225 offset:10240
    ds_read_b128 v[240:243], v225 offset:12288
    v_mfma_f32_16x16x32_bf16 v[36:39], v[212:215], v[168:171], v[36:39]
    ds_read_b128 v[244:247], v225 offset:14336
    v_mul_f32 v145, 0xbfb8aa3b, v147
    v_mfma_f32_16x16x1_4b_f32 v[0:15], v231, v144, v[0:15]
    v_mul_f32 v149, 0xbfb8aa3b, v151
    v_mul_f32 v153, 0xbfb8aa3b, v155
    v_mfma_f32_16x16x32_bf16 v[40:43], v[216:219], v[168:171], v[40:43]
    v_mul_f32 v157, 0xbfb8aa3b, v159
    v_add_u32 v224, -49152, v224
    v_mfma_f32_16x16x32_bf16 v[44:47], v[220:223], v[168:171], v[44:47]
    v_add_u32 v225, -49152, v225
    v_add_u32 v226, -49152, v226
    v_mfma_f32_16x16x32_bf16 v[60:63], v[220:223], v[172:175], v[60:63]
    v_add_u32 v227, -49152, v227
    v_mfma_f32_16x16x32_bf16 v[56:59], v[216:219], v[172:175], v[56:59]
    v_mfma_f32_16x16x32_bf16 v[52:55], v[212:215], v[172:175], v[52:55]
    v_mfma_f32_16x16x32_bf16 v[48:51], v[208:211], v[172:175], v[48:51]
    s_waitcnt lgkmcnt(0)
    s_barrier
    s_nop 1
    v_pk_mul_f32 v[176:177], v[0:1], v[144:145] op_sel:[0,1] op_sel_hi:[1,1]
    v_pk_mul_f32 v[178:179], v[2:3], v[144:145] op_sel:[0,1] op_sel_hi:[1,1]
    v_pk_mul_f32 v[180:181], v[4:5], v[144:145] op_sel:[0,1] op_sel_hi:[1,1]
    v_pk_mul_f32 v[182:183], v[6:7], v[144:145] op_sel:[0,1] op_sel_hi:[1,1]
    v_mfma_f32_16x16x1_4b_f32 v[16:31], v231, v148, v[16:31]
    v_exp_f32 v176, v176
    v_exp_f32 v177, v177
    v_exp_f32 v178, v178
    v_exp_f32 v179, v179
    v_exp_f32 v180, v180
    v_exp_f32 v181, v181
    v_exp_f32 v182, v182
    v_exp_f32 v183, v183
    v_pk_fma_f32 v[176:177], v[176:177], v[146:147], v[146:147] op_sel:[0,0,0] op_sel_hi:[1,0,0]
    v_pk_fma_f32 v[178:179], v[178:179], v[146:147], v[146:147] op_sel:[0,0,0] op_sel_hi:[1,0,0]
    v_pk_fma_f32 v[180:181], v[180:181], v[146:147], v[146:147] op_sel:[0,0,0] op_sel_hi:[1,0,0]
    v_pk_fma_f32 v[182:183], v[182:183], v[146:147], v[146:147] op_sel:[0,0,0] op_sel_hi:[1,0,0]
    v_rcp_f32 v176, v176
    v_pk_mul_f32 v[0:1], v[0:1], v[8:9]
    v_rcp_f32 v177, v177
    v_pk_mul_f32 v[2:3], v[2:3], v[10:11]
    v_rcp_f32 v178, v178
    v_pk_mul_f32 v[4:5], v[4:5], v[12:13]
    v_rcp_f32 v179, v179
    v_pk_mul_f32 v[6:7], v[6:7], v[14:15]
    v_rcp_f32 v180, v180
    v_pk_mul_f32 v[168:169], v[16:17], v[148:149] op_sel:[0,1] op_sel_hi:[1,1]
    v_rcp_f32 v181, v181
    v_pk_mul_f32 v[170:171], v[18:19], v[148:149] op_sel:[0,1] op_sel_hi:[1,1]
    v_rcp_f32 v182, v182
    v_pk_mul_f32 v[172:173], v[20:21], v[148:149] op_sel:[0,1] op_sel_hi:[1,1]
    v_rcp_f32 v183, v183
    v_pk_mul_f32 v[174:175], v[22:23], v[148:149] op_sel:[0,1] op_sel_hi:[1,1]
    v_pk_mul_f32 v[0:1], v[0:1], v[176:177]
    v_pk_mul_f32 v[2:3], v[2:3], v[178:179]
    v_pk_mul_f32 v[4:5], v[4:5], v[180:181]
    v_pk_mul_f32 v[6:7], v[6:7], v[182:183]
    v_mfma_f32_16x16x1_4b_f32 v[32:47], v231, v152, v[32:47]
    v_exp_f32 v168, v168
    v_cvt_pk_bf16_f32 v184, v0, v1
    v_exp_f32 v169, v169
    v_cvt_pk_bf16_f32 v185, v2, v3
    v_exp_f32 v170, v170
    v_cvt_pk_bf16_f32 v186, v4, v5
    v_exp_f32 v171, v171
    v_cvt_pk_bf16_f32 v187, v6, v7
    v_exp_f32 v172, v172
    buffer_store_dwordx4 v[184:187], v230, s[20:23], s90 offen sc1
    s_add_u32 s90, s90, 57344
    v_exp_f32 v173, v173
    v_exp_f32 v174, v174
    v_exp_f32 v175, v175
    v_pk_fma_f32 v[168:169], v[168:169], v[150:151], v[150:151] op_sel:[0,0,0] op_sel_hi:[1,0,0]
    v_pk_fma_f32 v[170:171], v[170:171], v[150:151], v[150:151] op_sel:[0,0,0] op_sel_hi:[1,0,0]
    v_pk_fma_f32 v[172:173], v[172:173], v[150:151], v[150:151] op_sel:[0,0,0] op_sel_hi:[1,0,0]
    v_pk_fma_f32 v[174:175], v[174:175], v[150:151], v[150:151] op_sel:[0,0,0] op_sel_hi:[1,0,0]
    v_rcp_f32 v168, v168
    v_pk_mul_f32 v[16:17], v[16:17], v[24:25]
    v_rcp_f32 v169, v169
    v_pk_mul_f32 v[18:19], v[18:19], v[26:27]
    v_rcp_f32 v170, v170
    v_pk_mul_f32 v[20:21], v[20:21], v[28:29]
    v_rcp_f32 v171, v171
    v_pk_mul_f32 v[22:23], v[22:23], v[30:31]
    v_rcp_f32 v172, v172
    v_pk_mul_f32 v[176:177], v[32:33], v[152:153] op_sel:[0,1] op_sel_hi:[1,1]
    v_rcp_f32 v173, v173
    v_pk_mul_f32 v[178:179], v[34:35], v[152:153] op_sel:[0,1] op_sel_hi:[1,1]
    v_rcp_f32 v174, v174
    v_pk_mul_f32 v[180:181], v[36:37], v[152:153] op_sel:[0,1] op_sel_hi:[1,1]
    v_rcp_f32 v175, v175
    v_pk_mul_f32 v[182:183], v[38:39], v[152:153] op_sel:[0,1] op_sel_hi:[1,1]
    v_pk_mul_f32 v[16:17], v[16:17], v[168:169]
    v_pk_mul_f32 v[18:19], v[18:19], v[170:171]
    v_pk_mul_f32 v[20:21], v[20:21], v[172:173]
    v_pk_mul_f32 v[22:23], v[22:23], v[174:175]
    v_mfma_f32_16x16x1_4b_f32 v[48:63], v231, v156, v[48:63]
    v_exp_f32 v176, v176
    v_cvt_pk_bf16_f32 v188, v16, v17
    v_exp_f32 v177, v177
    v_cvt_pk_bf16_f32 v189, v18, v19
    v_exp_f32 v178, v178
    v_cvt_pk_bf16_f32 v190, v20, v21
    v_exp_f32 v179, v179
    v_cvt_pk_bf16_f32 v191, v22, v23
    v_exp_f32 v180, v180
    buffer_store_dwordx4 v[188:191], v230, s[20:23], s90 offen sc1
    s_add_u32 s90, s90, 57344
    v_exp_f32 v181, v181
    v_exp_f32 v182, v182
    v_exp_f32 v183, v183
    v_pk_fma_f32 v[176:177], v[176:177], v[154:155], v[154:155] op_sel:[0,0,0] op_sel_hi:[1,0,0]
    v_pk_fma_f32 v[178:179], v[178:179], v[154:155], v[154:155] op_sel:[0,0,0] op_sel_hi:[1,0,0]
    v_pk_fma_f32 v[180:181], v[180:181], v[154:155], v[154:155] op_sel:[0,0,0] op_sel_hi:[1,0,0]
    v_pk_fma_f32 v[182:183], v[182:183], v[154:155], v[154:155] op_sel:[0,0,0] op_sel_hi:[1,0,0]
    v_rcp_f32 v176, v176
    v_pk_mul_f32 v[32:33], v[32:33], v[40:41]
    v_rcp_f32 v177, v177
    v_pk_mul_f32 v[34:35], v[34:35], v[42:43]
    v_rcp_f32 v178, v178
    v_pk_mul_f32 v[36:37], v[36:37], v[44:45]
    v_rcp_f32 v179, v179
    v_pk_mul_f32 v[38:39], v[38:39], v[46:47]
    v_rcp_f32 v180, v180
    v_pk_mul_f32 v[168:169], v[48:49], v[156:157] op_sel:[0,1] op_sel_hi:[1,1]
    v_rcp_f32 v181, v181
    v_pk_mul_f32 v[170:171], v[50:51], v[156:157] op_sel:[0,1] op_sel_hi:[1,1]
    v_rcp_f32 v182, v182
    v_pk_mul_f32 v[172:173], v[52:53], v[156:157] op_sel:[0,1] op_sel_hi:[1,1]
    v_rcp_f32 v183, v183
    v_pk_mul_f32 v[174:175], v[54:55], v[156:157] op_sel:[0,1] op_sel_hi:[1,1]
    v_pk_mul_f32 v[32:33], v[32:33], v[176:177]
    v_pk_mul_f32 v[34:35], v[34:35], v[178:179]
    v_pk_mul_f32 v[36:37], v[36:37], v[180:181]
    v_pk_mul_f32 v[38:39], v[38:39], v[182:183]
    v_exp_f32 v168, v168
    v_cvt_pk_bf16_f32 v184, v32, v33
    v_exp_f32 v169, v169
    v_cvt_pk_bf16_f32 v185, v34, v35
    v_exp_f32 v170, v170
    v_cvt_pk_bf16_f32 v186, v36, v37
    v_exp_f32 v171, v171
    v_cvt_pk_bf16_f32 v187, v38, v39
    v_exp_f32 v172, v172
    buffer_store_dwordx4 v[184:187], v230, s[20:23], s90 offen sc1
    s_add_u32 s90, s90, 57344
    v_exp_f32 v173, v173
    v_exp_f32 v174, v174
    v_exp_f32 v175, v175
    v_pk_fma_f32 v[168:169], v[168:169], v[158:159], v[158:159] op_sel:[0,0,0] op_sel_hi:[1,0,0]
    v_pk_fma_f32 v[170:171], v[170:171], v[158:159], v[158:159] op_sel:[0,0,0] op_sel_hi:[1,0,0]
    v_pk_fma_f32 v[172:173], v[172:173], v[158:159], v[158:159] op_sel:[0,0,0] op_sel_hi:[1,0,0]
    v_pk_fma_f32 v[174:175], v[174:175], v[158:159], v[158:159] op_sel:[0,0,0] op_sel_hi:[1,0,0]
    v_rcp_f32 v168, v168
    v_pk_mul_f32 v[48:49], v[48:49], v[56:57]
    v_rcp_f32 v169, v169
    v_pk_mul_f32 v[50:51], v[50:51], v[58:59]
    v_rcp_f32 v170, v170
    v_pk_mul_f32 v[52:53], v[52:53], v[60:61]
    v_rcp_f32 v171, v171
    v_pk_mul_f32 v[54:55], v[54:55], v[62:63]
    v_rcp_f32 v172, v172
    v_rcp_f32 v173, v173
    v_rcp_f32 v174, v174
    v_rcp_f32 v175, v175
    v_pk_mul_f32 v[48:49], v[48:49], v[168:169]
    v_pk_mul_f32 v[50:51], v[50:51], v[170:171]
    v_pk_mul_f32 v[52:53], v[52:53], v[172:173]
    v_pk_mul_f32 v[54:55], v[54:55], v[174:175]
    v_cvt_pk_bf16_f32 v188, v48, v49
    v_cvt_pk_bf16_f32 v189, v50, v51
    v_cvt_pk_bf16_f32 v190, v52, v53
    v_cvt_pk_bf16_f32 v191, v54, v55
    buffer_store_dwordx4 v[188:191], v230, s[20:23], s90 offen sc1
    v_mfma_f32_16x16x32_bf16 v[64:67], v[192:195], v[128:131], v[64:67]
    ds_read_b64_tr_b16 v[16:17], v226 offset:16384
    ds_read_b64_tr_b16 v[18:19], v226 offset:17408
    v_mfma_f32_16x16x32_bf16 v[68:71], v[196:199], v[128:131], v[68:71]
    ds_read_b64_tr_b16 v[20:21], v227 offset:16384
    ds_read_b64_tr_b16 v[22:23], v227 offset:17408
    v_mfma_f32_16x16x32_bf16 v[72:75], v[200:203], v[128:131], v[72:75]
    ds_read_b64_tr_b16 v[24:25], v226 offset:32768
    ds_read_b64_tr_b16 v[26:27], v226 offset:33792
    v_mfma_f32_16x16x32_bf16 v[76:79], v[204:207], v[128:131], v[76:79]
    ds_read_b64_tr_b16 v[28:29], v227 offset:32768
    ds_read_b64_tr_b16 v[30:31], v227 offset:33792
    v_mfma_f32_16x16x32_bf16 v[92:95], v[204:207], v[132:135], v[92:95]
    ds_read_b128 v[0:3], v224 offset:8192
    ds_read_b128 v[4:7], v224 offset:10240
    v_mfma_f32_16x16x32_bf16 v[88:91], v[200:203], v[132:135], v[88:91]
    ds_read_b128 v[8:11], v224 offset:12288
    ds_read_b128 v[12:15], v224 offset:14336
    v_mfma_f32_16x16x32_bf16 v[84:87], v[196:199], v[132:135], v[84:87]
    ds_read_b64_tr_b16 v[48:49], v226 offset:24576
    ds_read_b64_tr_b16 v[50:51], v226 offset:25600
    v_mfma_f32_16x16x32_bf16 v[80:83], v[192:195], v[132:135], v[80:83]
    ds_read_b64_tr_b16 v[52:53], v227 offset:24576
    ds_read_b64_tr_b16 v[54:55], v227 offset:25600
    v_mfma_f32_16x16x32_bf16 v[96:99], v[192:195], v[136:139], v[96:99]
    ds_read_b64_tr_b16 v[56:57], v226 offset:40960
    ds_read_b64_tr_b16 v[58:59], v226 offset:41984
    v_mfma_f32_16x16x32_bf16 v[100:103], v[196:199], v[136:139], v[100:103]
    ds_read_b64_tr_b16 v[60:61], v227 offset:40960
    ds_read_b64_tr_b16 v[62:63], v227 offset:41984
    v_mfma_f32_16x16x32_bf16 v[104:107], v[200:203], v[136:139], v[104:107]
    ds_read_b128 v[32:35], v225 offset:8192
    ds_read_b128 v[36:39], v225 offset:10240
    v_mfma_f32_16x16x32_bf16 v[108:111], v[204:207], v[136:139], v[108:111]
    ds_read_b128 v[40:43], v225 offset:12288
    ds_read_b128 v[44:47], v225 offset:14336
    v_mfma_f32_16x16x32_bf16 v[124:127], v[204:207], v[140:143], v[124:127]
    v_mfma_f32_16x16x32_bf16 v[120:123], v[200:203], v[140:143], v[120:123]
    v_mfma_f32_16x16x32_bf16 v[116:119], v[196:199], v[140:143], v[116:119]
    v_mfma_f32_16x16x32_bf16 v[112:115], v[192:195], v[140:143], v[112:115]
    v_mfma_f32_16x16x32_bf16 v[64:67], v[208:211], v[232:235], v[64:67]
    v_mfma_f32_16x16x32_bf16 v[68:71], v[212:215], v[232:235], v[68:71]
    v_mfma_f32_16x16x32_bf16 v[72:75], v[216:219], v[232:235], v[72:75]
    v_mfma_f32_16x16x32_bf16 v[76:79], v[220:223], v[232:235], v[76:79]
    s_waitcnt lgkmcnt(0)
    s_barrier
    v_mfma_f32_16x16x32_bf16 v[92:95], v[220:223], v[236:239], v[92:95]
    ds_read_b128 v[144:147], v229 offset:1024
    ds_read_b128 v[148:151], v229 offset:1280
    v_mfma_f32_16x16x32_bf16 v[88:91], v[216:219], v[236:239], v[88:91]
    ds_read_b128 v[152:155], v229 offset:1536
    ds_read_b128 v[156:159], v229 offset:1792
    v_mfma_f32_16x16x32_bf16 v[84:87], v[212:215], v[236:239], v[84:87]
    v_mfma_f32_16x16x32_bf16 v[80:83], v[208:211], v[236:239], v[80:83]
    v_mfma_f32_16x16x32_bf16 v[96:99], v[208:211], v[240:243], v[96:99]
    v_mfma_f32_16x16x32_bf16 v[100:103], v[212:215], v[240:243], v[100:103]
    v_mfma_f32_16x16x32_bf16 v[104:107], v[216:219], v[240:243], v[104:107]
    v_mfma_f32_16x16x32_bf16 v[108:111], v[220:223], v[240:243], v[108:111]
    v_mfma_f32_16x16x32_bf16 v[124:127], v[220:223], v[244:247], v[124:127]
    v_mfma_f32_16x16x32_bf16 v[120:123], v[216:219], v[244:247], v[120:123]
    v_mfma_f32_16x16x32_bf16 v[116:119], v[212:215], v[244:247], v[116:119]
    v_mfma_f32_16x16x32_bf16 v[112:115], v[208:211], v[244:247], v[112:115]
    s_waitcnt lgkmcnt(0)
    v_mfma_f32_16x16x32_bf16 v[64:67], v[16:19], v[0:3], v[64:67]
    s_mov_b32 s90, s92
    v_mfma_f32_16x16x32_bf16 v[68:71], v[20:23], v[0:3], v[68:71]
    v_and_b32 v144, 0xffff0000, v144
    v_mfma_f32_16x16x32_bf16 v[72:75], v[24:27], v[0:3], v[72:75]
    v_and_b32 v148, 0xffff0000, v148
    v_mfma_f32_16x16x32_bf16 v[76:79], v[28:31], v[0:3], v[76:79]
    v_and_b32 v152, 0xffff0000, v152
    v_mfma_f32_16x16x32_bf16 v[92:95], v[28:31], v[4:7], v[92:95]
    v_and_b32 v156, 0xffff0000, v156
    v_mfma_f32_16x16x32_bf16 v[88:91], v[24:27], v[4:7], v[88:91]
    v_mul_f32 v145, 0xbfb8aa3b, v147
    v_mfma_f32_16x16x32_bf16 v[84:87], v[20:23], v[4:7], v[84:87]
    v_mul_f32 v149, 0xbfb8aa3b, v151
    v_mfma_f32_16x16x32_bf16 v[80:83], v[16:19], v[4:7], v[80:83]
    v_mul_f32 v153, 0xbfb8aa3b, v155
    v_mfma_f32_16x16x32_bf16 v[96:99], v[16:19], v[8:11], v[96:99]
    v_mul_f32 v157, 0xbfb8aa3b, v159
    v_mfma_f32_16x16x32_bf16 v[100:103], v[20:23], v[8:11], v[100:103]
    v_mfma_f32_16x16x32_bf16 v[104:107], v[24:27], v[8:11], v[104:107]
    v_mfma_f32_16x16x32_bf16 v[108:111], v[28:31], v[8:11], v[108:111]
    v_mfma_f32_16x16x32_bf16 v[124:127], v[28:31], v[12:15], v[124:127]
    v_mfma_f32_16x16x32_bf16 v[120:123], v[24:27], v[12:15], v[120:123]
    v_mfma_f32_16x16x32_bf16 v[116:119], v[20:23], v[12:15], v[116:119]
    v_mfma_f32_16x16x32_bf16 v[112:115], v[16:19], v[12:15], v[112:115]
    s_waitcnt vmcnt(0)
    s_barrier
    v_mfma_f32_16x16x32_bf16 v[64:67], v[48:51], v[32:35], v[64:67]
    v_mfma_f32_16x16x32_bf16 v[68:71], v[52:55], v[32:35], v[68:71]
    v_mfma_f32_16x16x32_bf16 v[72:75], v[56:59], v[32:35], v[72:75]
    v_mfma_f32_16x16x32_bf16 v[76:79], v[60:63], v[32:35], v[76:79]
    v_mfma_f32_16x16x32_bf16 v[92:95], v[60:63], v[36:39], v[92:95]
    v_mfma_f32_16x16x32_bf16 v[88:91], v[56:59], v[36:39], v[88:91]
    v_mfma_f32_16x16x32_bf16 v[84:87], v[52:55], v[36:39], v[84:87]
    v_mfma_f32_16x16x32_bf16 v[80:83], v[48:51], v[36:39], v[80:83]
    v_mfma_f32_16x16x32_bf16 v[96:99], v[48:51], v[40:43], v[96:99]
    v_mfma_f32_16x16x32_bf16 v[100:103], v[52:55], v[40:43], v[100:103]
    v_mfma_f32_16x16x1_4b_f32 v[64:79], v231, v144, v[64:79]
    v_mfma_f32_16x16x32_bf16 v[104:107], v[56:59], v[40:43], v[104:107]
    v_mfma_f32_16x16x32_bf16 v[108:111], v[60:63], v[40:43], v[108:111]
    v_mfma_f32_16x16x32_bf16 v[124:127], v[60:63], v[44:47], v[124:127]
    v_mfma_f32_16x16x32_bf16 v[120:123], v[56:59], v[44:47], v[120:123]
    v_mfma_f32_16x16x32_bf16 v[116:119], v[52:55], v[44:47], v[116:119]
    v_mfma_f32_16x16x32_bf16 v[112:115], v[48:51], v[44:47], v[112:115]
    s_nop 3
    v_pk_mul_f32 v[176:177], v[64:65], v[144:145] op_sel:[0,1] op_sel_hi:[1,1]
    v_pk_mul_f32 v[178:179], v[66:67], v[144:145] op_sel:[0,1] op_sel_hi:[1,1]
    v_pk_mul_f32 v[180:181], v[68:69], v[144:145] op_sel:[0,1] op_sel_hi:[1,1]
    v_pk_mul_f32 v[182:183], v[70:71], v[144:145] op_sel:[0,1] op_sel_hi:[1,1]
    v_mfma_f32_16x16x1_4b_f32 v[80:95], v231, v148, v[80:95]
    v_exp_f32 v176, v176
    v_exp_f32 v177, v177
    v_exp_f32 v178, v178
    v_exp_f32 v179, v179
    v_exp_f32 v180, v180
    v_exp_f32 v181, v181
    v_exp_f32 v182, v182
    v_exp_f32 v183, v183
    v_pk_fma_f32 v[176:177], v[176:177], v[146:147], v[146:147] op_sel:[0,0,0] op_sel_hi:[1,0,0]
    v_pk_fma_f32 v[178:179], v[178:179], v[146:147], v[146:147] op_sel:[0,0,0] op_sel_hi:[1,0,0]
    v_pk_fma_f32 v[180:181], v[180:181], v[146:147], v[146:147] op_sel:[0,0,0] op_sel_hi:[1,0,0]
    v_pk_fma_f32 v[182:183], v[182:183], v[146:147], v[146:147] op_sel:[0,0,0] op_sel_hi:[1,0,0]
    v_rcp_f32 v176, v176
    v_pk_mul_f32 v[64:65], v[64:65], v[72:73]
    v_rcp_f32 v177, v177
    v_pk_mul_f32 v[66:67], v[66:67], v[74:75]
    v_rcp_f32 v178, v178
    v_pk_mul_f32 v[68:69], v[68:69], v[76:77]
    v_rcp_f32 v179, v179
    v_pk_mul_f32 v[70:71], v[70:71], v[78:79]
    v_rcp_f32 v180, v180
    v_pk_mul_f32 v[168:169], v[80:81], v[148:149] op_sel:[0,1] op_sel_hi:[1,1]
    v_rcp_f32 v181, v181
    v_pk_mul_f32 v[170:171], v[82:83], v[148:149] op_sel:[0,1] op_sel_hi:[1,1]
    v_rcp_f32 v182, v182
    v_pk_mul_f32 v[172:173], v[84:85], v[148:149] op_sel:[0,1] op_sel_hi:[1,1]
    v_rcp_f32 v183, v183
    v_pk_mul_f32 v[174:175], v[86:87], v[148:149] op_sel:[0,1] op_sel_hi:[1,1]
    v_pk_mul_f32 v[64:65], v[64:65], v[176:177]
    v_pk_mul_f32 v[66:67], v[66:67], v[178:179]
    v_pk_mul_f32 v[68:69], v[68:69], v[180:181]
    v_pk_mul_f32 v[70:71], v[70:71], v[182:183]
    v_mfma_f32_16x16x1_4b_f32 v[96:111], v231, v152, v[96:111]
    v_exp_f32 v168, v168
    v_cvt_pk_bf16_f32 v184, v64, v65
    v_exp_f32 v169, v169
    v_cvt_pk_bf16_f32 v185, v66, v67
    v_exp_f32 v170, v170
    v_cvt_pk_bf16_f32 v186, v68, v69
    v_exp_f32 v171, v171
    v_cvt_pk_bf16_f32 v187, v70, v71
    v_exp_f32 v172, v172
    buffer_store_dwordx4 v[184:187], v230, s[20:23], s90 offen sc1
    s_add_u32 s90, s90, 57344
    v_exp_f32 v173, v173
    v_exp_f32 v174, v174
    v_exp_f32 v175, v175
    v_pk_fma_f32 v[168:169], v[168:169], v[150:151], v[150:151] op_sel:[0,0,0] op_sel_hi:[1,0,0]
    v_pk_fma_f32 v[170:171], v[170:171], v[150:151], v[150:151] op_sel:[0,0,0] op_sel_hi:[1,0,0]
    v_pk_fma_f32 v[172:173], v[172:173], v[150:151], v[150:151] op_sel:[0,0,0] op_sel_hi:[1,0,0]
    v_pk_fma_f32 v[174:175], v[174:175], v[150:151], v[150:151] op_sel:[0,0,0] op_sel_hi:[1,0,0]
    v_rcp_f32 v168, v168
    v_pk_mul_f32 v[80:81], v[80:81], v[88:89]
    v_rcp_f32 v169, v169
    v_pk_mul_f32 v[82:83], v[82:83], v[90:91]
    v_rcp_f32 v170, v170
    v_pk_mul_f32 v[84:85], v[84:85], v[92:93]
    v_rcp_f32 v171, v171
    v_pk_mul_f32 v[86:87], v[86:87], v[94:95]
    v_rcp_f32 v172, v172
    v_pk_mul_f32 v[176:177], v[96:97], v[152:153] op_sel:[0,1] op_sel_hi:[1,1]
    v_rcp_f32 v173, v173
    v_pk_mul_f32 v[178:179], v[98:99], v[152:153] op_sel:[0,1] op_sel_hi:[1,1]
    v_rcp_f32 v174, v174
    v_pk_mul_f32 v[180:181], v[100:101], v[152:153] op_sel:[0,1] op_sel_hi:[1,1]
    v_rcp_f32 v175, v175
    v_pk_mul_f32 v[182:183], v[102:103], v[152:153] op_sel:[0,1] op_sel_hi:[1,1]
    v_pk_mul_f32 v[80:81], v[80:81], v[168:169]
    v_pk_mul_f32 v[82:83], v[82:83], v[170:171]
    v_pk_mul_f32 v[84:85], v[84:85], v[172:173]
    v_pk_mul_f32 v[86:87], v[86:87], v[174:175]
    v_mfma_f32_16x16x1_4b_f32 v[112:127], v231, v156, v[112:127]
    v_exp_f32 v176, v176
    v_cvt_pk_bf16_f32 v188, v80, v81
    v_exp_f32 v177, v177
    v_cvt_pk_bf16_f32 v189, v82, v83
    v_exp_f32 v178, v178
    v_cvt_pk_bf16_f32 v190, v84, v85
    v_exp_f32 v179, v179
    v_cvt_pk_bf16_f32 v191, v86, v87
    v_exp_f32 v180, v180
    buffer_store_dwordx4 v[188:191], v230, s[20:23], s90 offen sc1
    s_add_u32 s90, s90, 57344
    v_exp_f32 v181, v181
    v_exp_f32 v182, v182
    v_exp_f32 v183, v183
    v_pk_fma_f32 v[176:177], v[176:177], v[154:155], v[154:155] op_sel:[0,0,0] op_sel_hi:[1,0,0]
    v_pk_fma_f32 v[178:179], v[178:179], v[154:155], v[154:155] op_sel:[0,0,0] op_sel_hi:[1,0,0]
    v_pk_fma_f32 v[180:181], v[180:181], v[154:155], v[154:155] op_sel:[0,0,0] op_sel_hi:[1,0,0]
    v_pk_fma_f32 v[182:183], v[182:183], v[154:155], v[154:155] op_sel:[0,0,0] op_sel_hi:[1,0,0]
    v_rcp_f32 v176, v176
    v_pk_mul_f32 v[96:97], v[96:97], v[104:105]
    v_rcp_f32 v177, v177
    v_pk_mul_f32 v[98:99], v[98:99], v[106:107]
    v_rcp_f32 v178, v178
    v_pk_mul_f32 v[100:101], v[100:101], v[108:109]
    v_rcp_f32 v179, v179
    v_pk_mul_f32 v[102:103], v[102:103], v[110:111]
    v_rcp_f32 v180, v180
    v_pk_mul_f32 v[168:169], v[112:113], v[156:157] op_sel:[0,1] op_sel_hi:[1,1]
    v_rcp_f32 v181, v181
    v_pk_mul_f32 v[170:171], v[114:115], v[156:157] op_sel:[0,1] op_sel_hi:[1,1]
    v_rcp_f32 v182, v182
    v_pk_mul_f32 v[172:173], v[116:117], v[156:157] op_sel:[0,1] op_sel_hi:[1,1]
    v_rcp_f32 v183, v183
    v_pk_mul_f32 v[174:175], v[118:119], v[156:157] op_sel:[0,1] op_sel_hi:[1,1]
    v_pk_mul_f32 v[96:97], v[96:97], v[176:177]
    v_pk_mul_f32 v[98:99], v[98:99], v[178:179]
    v_pk_mul_f32 v[100:101], v[100:101], v[180:181]
    v_pk_mul_f32 v[102:103], v[102:103], v[182:183]
    v_exp_f32 v168, v168
    v_cvt_pk_bf16_f32 v184, v96, v97
    v_exp_f32 v169, v169
    v_cvt_pk_bf16_f32 v185, v98, v99
    v_exp_f32 v170, v170
    v_cvt_pk_bf16_f32 v186, v100, v101
    v_exp_f32 v171, v171
    v_cvt_pk_bf16_f32 v187, v102, v103
    v_exp_f32 v172, v172
    buffer_store_dwordx4 v[184:187], v230, s[20:23], s90 offen sc1
    s_add_u32 s90, s90, 57344
    v_exp_f32 v173, v173
    v_exp_f32 v174, v174
    v_exp_f32 v175, v175
    v_pk_fma_f32 v[168:169], v[168:169], v[158:159], v[158:159] op_sel:[0,0,0] op_sel_hi:[1,0,0]
    v_pk_fma_f32 v[170:171], v[170:171], v[158:159], v[158:159] op_sel:[0,0,0] op_sel_hi:[1,0,0]
    v_pk_fma_f32 v[172:173], v[172:173], v[158:159], v[158:159] op_sel:[0,0,0] op_sel_hi:[1,0,0]
    v_pk_fma_f32 v[174:175], v[174:175], v[158:159], v[158:159] op_sel:[0,0,0] op_sel_hi:[1,0,0]
    v_rcp_f32 v168, v168
    v_pk_mul_f32 v[112:113], v[112:113], v[120:121]
    v_rcp_f32 v169, v169
    v_pk_mul_f32 v[114:115], v[114:115], v[122:123]
    v_rcp_f32 v170, v170
    v_pk_mul_f32 v[116:117], v[116:117], v[124:125]
    v_rcp_f32 v171, v171
    v_pk_mul_f32 v[118:119], v[118:119], v[126:127]
    v_rcp_f32 v172, v172
    v_rcp_f32 v173, v173
    v_rcp_f32 v174, v174
    v_rcp_f32 v175, v175
    v_pk_mul_f32 v[112:113], v[112:113], v[168:169]
    v_pk_mul_f32 v[114:115], v[114:115], v[170:171]
    v_pk_mul_f32 v[116:117], v[116:117], v[172:173]
    v_pk_mul_f32 v[118:119], v[118:119], v[174:175]
    v_cvt_pk_bf16_f32 v188, v112, v113
    v_cvt_pk_bf16_f32 v189, v114, v115
    v_cvt_pk_bf16_f32 v190, v116, v117
    v_cvt_pk_bf16_f32 v191, v118, v119
    buffer_store_dwordx4 v[188:191], v230, s[20:23], s90 offen sc1
L_stage2_4:
    v_and_b32 v38, 15, v255
    v_lshrrev_b32 v34, 4, v255
    v_lshrrev_b32 v35, 2, v38
    v_and_b32 v36, 3, v38
    v_lshl_add_u32 v35, v34, 2, v35
    v_bfe_u32 v37, v35, 1, 2
    s_lshl_b32 s62, s74, 1
    v_xor_b32 v37, s62, v37
    v_lshlrev_b32 v37, 5, v37
    v_lshl_add_u32 v37, v36, 3, v37
    v_lshl_add_u32 v37, v35, 7, v37
    s_lshl_b32 s62, s74, 12
    v_add_u32 v232, s62, v37
    v_xor_b32 v233, 32, v232
    v_xor_b32 v234, 64, v232
    v_xor_b32 v235, 96, v232
    v_add_u32 v236, 0x10000, v232
    v_add_u32 v237, 0x10000, v233
    v_add_u32 v238, 0x10000, v234
    v_add_u32 v239, 0x10000, v235
    ds_read_b64_tr_b16 v[80:81], v236 offset:32768
    v_add_u32 v240, 0x20000, v232
    ds_read_b64_tr_b16 v[82:83], v236 offset:34816
    v_add_u32 v241, 0x20000, v233
    ds_read_b64_tr_b16 v[84:85], v237 offset:32768
    v_add_u32 v242, 0x20000, v234
    ds_read_b64_tr_b16 v[86:87], v237 offset:34816
    v_add_u32 v243, 0x20000, v235
    ds_read_b64_tr_b16 v[88:89], v238 offset:32768
    v_lshlrev_b32 v35, 15, v38
    ds_read_b64_tr_b16 v[90:91], v238 offset:34816
    v_and_b32 v36, 1, v34
    ds_read_b64_tr_b16 v[92:93], v239 offset:32768
    v_lshlrev_b32 v36, 5, v36
    ds_read_b64_tr_b16 v[94:95], v239 offset:34816
    v_lshrrev_b32 v37, 1, v34
    ds_read_b64_tr_b16 v[96:97], v236 offset:40960
    v_lshl_add_u32 v36, v37, 4, v36
    ds_read_b64_tr_b16 v[98:99], v236 offset:43008
    v_add_u32 v246, v35, v36
    ds_read_b64_tr_b16 v[100:101], v237 offset:40960
    v_lshl_add_u32 v37, s74, 2, v37
    ds_read_b64_tr_b16 v[102:103], v237 offset:43008
    v_xor_b32 v37, v37, v38
    ds_read_b64_tr_b16 v[104:105], v238 offset:40960
    v_and_b32 v37, 7, v37
    ds_read_b64_tr_b16 v[106:107], v238 offset:43008
    v_lshlrev_b32 v37, 4, v37
    ds_read_b64_tr_b16 v[108:109], v239 offset:40960
    v_and_b32 v36, 1, v34
    ds_read_b64_tr_b16 v[110:111], v239 offset:43008
    v_lshl_add_u32 v37, v36, 3, v37
    ds_read_b64_tr_b16 v[112:113], v236 offset:49152
    v_lshl_add_u32 v37, v38, 7, v37
    ds_read_b64_tr_b16 v[114:115], v236 offset:51200
    s_lshl_b32 s62, s75, 12
    ds_read_b64_tr_b16 v[116:117], v237 offset:49152
    s_add_u32 s62, s62, 155648
    ds_read_b64_tr_b16 v[118:119], v237 offset:51200
    v_add_u32 v247, s62, v37
    ds_read_b64_tr_b16 v[120:121], v238 offset:49152
    v_xor_b32 v248, 32, v247
    ds_read_b64_tr_b16 v[122:123], v238 offset:51200
    v_lshl_add_u32 v244, v255, 4, s79
    ds_read_b64_tr_b16 v[124:125], v239 offset:49152
    v_add_u32 v245, 57344, v244
    ds_read_b64_tr_b16 v[126:127], v239 offset:51200
    ds_read_b64_tr_b16 v[128:129], v236 offset:57344
    ds_read_b64_tr_b16 v[130:131], v236 offset:59392
    ds_read_b64_tr_b16 v[132:133], v237 offset:57344
    ds_read_b64_tr_b16 v[134:135], v237 offset:59392
    ds_read_b64_tr_b16 v[136:137], v238 offset:57344
    ds_read_b64_tr_b16 v[138:139], v238 offset:59392
    ds_read_b64_tr_b16 v[140:141], v239 offset:57344
    ds_read_b64_tr_b16 v[142:143], v239 offset:59392
    s_barrier
    buffer_load_dwordx4 v[32:35], v244, s[20:23], s80 offen offset:0 sc1
    buffer_load_dwordx4 v[36:39], v245, s[20:23], s80 offen offset:0 sc1
    buffer_load_dwordx4 v[40:43], v244, s[20:23], s80 offen offset:1024 sc1
    buffer_load_dwordx4 v[44:47], v245, s[20:23], s80 offen offset:1024 sc1
    buffer_load_dwordx4 v[48:51], v244, s[20:23], s81 offen offset:0 sc1
    buffer_load_dwordx4 v[52:55], v245, s[20:23], s81 offen offset:0 sc1
    ds_read_b64_tr_b16 v[144:145], v240 offset:0
    ds_read_b64_tr_b16 v[146:147], v240 offset:2048
    ds_read_b64_tr_b16 v[148:149], v241 offset:0
    ds_read_b64_tr_b16 v[150:151], v241 offset:2048
    ds_read_b64_tr_b16 v[152:153], v242 offset:0
    ds_read_b64_tr_b16 v[154:155], v242 offset:2048
    ds_read_b64_tr_b16 v[156:157], v243 offset:0
    ds_read_b64_tr_b16 v[158:159], v243 offset:2048
    ds_read_b64_tr_b16 v[160:161], v240 offset:8192
    ds_read_b64_tr_b16 v[162:163], v240 offset:10240
    ds_read_b64_tr_b16 v[164:165], v241 offset:8192
    ds_read_b64_tr_b16 v[166:167], v241 offset:10240
    ds_read_b64_tr_b16 v[168:169], v242 offset:8192
    ds_read_b64_tr_b16 v[170:171], v242 offset:10240
    ds_read_b64_tr_b16 v[172:173], v243 offset:8192
    ds_read_b64_tr_b16 v[174:175], v243 offset:10240
    ds_read_b64_tr_b16 v[176:177], v240 offset:16384
    ds_read_b64_tr_b16 v[178:179], v240 offset:18432
    ds_read_b64_tr_b16 v[180:181], v241 offset:16384
    ds_read_b64_tr_b16 v[182:183], v241 offset:18432
    ds_read_b64_tr_b16 v[184:185], v242 offset:16384
    ds_read_b64_tr_b16 v[186:187], v242 offset:18432
    ds_read_b64_tr_b16 v[188:189], v243 offset:16384
    ds_read_b64_tr_b16 v[190:191], v243 offset:18432
    ds_read_b64_tr_b16 v[192:193], v232 offset:49152
    ds_read_b64_tr_b16 v[194:195], v232 offset:51200
    ds_read_b64_tr_b16 v[196:197], v233 offset:49152
    ds_read_b64_tr_b16 v[198:199], v233 offset:51200
    ds_read_b64_tr_b16 v[200:201], v234 offset:49152
    ds_read_b64_tr_b16 v[202:203], v234 offset:51200
    ds_read_b64_tr_b16 v[204:205], v235 offset:49152
    ds_read_b64_tr_b16 v[206:207], v235 offset:51200
    ds_read_b64_tr_b16 v[208:209], v232 offset:57344
    ds_read_b64_tr_b16 v[210:211], v232 offset:59392
    ds_read_b64_tr_b16 v[212:213], v233 offset:57344
    ds_read_b64_tr_b16 v[214:215], v233 offset:59392
    ds_read_b64_tr_b16 v[216:217], v234 offset:57344
    ds_read_b64_tr_b16 v[218:219], v234 offset:59392
    ds_read_b64_tr_b16 v[220:221], v235 offset:57344
    ds_read_b64_tr_b16 v[222:223], v235 offset:59392
    s_waitcnt vmcnt(6) lgkmcnt(0)
    s_barrier
    buffer_load_dwordx4 v[56:59], v244, s[20:23], s81 offen offset:1024 sc1
    buffer_load_dwordx4 v[60:63], v245, s[20:23], s81 offen offset:1024 sc1
    buffer_load_dwordx4 v[64:67], v244, s[20:23], s82 offen offset:0 sc1
    buffer_load_dwordx4 v[68:71], v245, s[20:23], s82 offen offset:0 sc1
    buffer_load_dwordx4 v[72:75], v244, s[20:23], s82 offen offset:1024 sc1
    buffer_load_dwordx4 v[76:79], v245, s[20:23], s82 offen offset:1024 sc1
    s_waitcnt vmcnt(10)
    v_mfma_f32_16x16x32_bf16 v[0:3], v[80:83], v[32:35], 0
    v_mfma_f32_16x16x32_bf16 v[4:7], v[84:87], v[32:35], 0
    v_mfma_f32_16x16x32_bf16 v[8:11], v[88:91], v[32:35], 0
    v_mfma_f32_16x16x32_bf16 v[12:15], v[92:95], v[32:35], 0
    buffer_load_dwordx4 v[32:35], v244, s[20:23], s83 offen offset:0 sc1
    v_mfma_f32_16x16x32_bf16 v[28:31], v[92:95], v[36:39], 0
    v_mfma_f32_16x16x32_bf16 v[24:27], v[88:91], v[36:39], 0
    v_mfma_f32_16x16x32_bf16 v[20:23], v[84:87], v[36:39], 0
    v_mfma_f32_16x16x32_bf16 v[16:19], v[80:83], v[36:39], 0
    buffer_load_dwordx4 v[36:39], v245, s[20:23], s83 offen offset:0 sc1
    s_waitcnt vmcnt(10)
    v_mfma_f32_16x16x32_bf16 v[0:3], v[96:99], v[40:43], v[0:3]
    v_mfma_f32_16x16x32_bf16 v[4:7], v[100:103], v[40:43], v[4:7]
    v_mfma_f32_16x16x32_bf16 v[8:11], v[104:107], v[40:43], v[8:11]
    v_mfma_f32_16x16x32_bf16 v[12:15], v[108:111], v[40:43], v[12:15]
    buffer_load_dwordx4 v[40:43], v244, s[20:23], s83 offen offset:1024 sc1
    v_mfma_f32_16x16x32_bf16 v[28:31], v[108:111], v[44:47], v[28:31]
    v_mfma_f32_16x16x32_bf16 v[24:27], v[104:107], v[44:47], v[24:27]
    v_mfma_f32_16x16x32_bf16 v[20:23], v[100:103], v[44:47], v[20:23]
    v_mfma_f32_16x16x32_bf16 v[16:19], v[96:99], v[44:47], v[16:19]
    buffer_load_dwordx4 v[44:47], v245, s[20:23], s83 offen offset:1024 sc1
    s_waitcnt vmcnt(10)
    v_mfma_f32_16x16x32_bf16 v[0:3], v[112:115], v[48:51], v[0:3]
    v_mfma_f32_16x16x32_bf16 v[4:7], v[116:119], v[48:51], v[4:7]
    v_mfma_f32_16x16x32_bf16 v[8:11], v[120:123], v[48:51], v[8:11]
    v_mfma_f32_16x16x32_bf16 v[12:15], v[124:127], v[48:51], v[12:15]
    buffer_load_dwordx4 v[48:51], v244, s[20:23], s84 offen offset:0 sc1
    v_mfma_f32_16x16x32_bf16 v[28:31], v[124:127], v[52:55], v[28:31]
    v_mfma_f32_16x16x32_bf16 v[24:27], v[120:123], v[52:55], v[24:27]
    v_mfma_f32_16x16x32_bf16 v[20:23], v[116:119], v[52:55], v[20:23]
    v_mfma_f32_16x16x32_bf16 v[16:19], v[112:115], v[52:55], v[16:19]
    buffer_load_dwordx4 v[52:55], v245, s[20:23], s84 offen offset:0 sc1
    s_waitcnt vmcnt(10)
    v_mfma_f32_16x16x32_bf16 v[0:3], v[128:131], v[56:59], v[0:3]
    v_mfma_f32_16x16x32_bf16 v[4:7], v[132:135], v[56:59], v[4:7]
    v_mfma_f32_16x16x32_bf16 v[8:11], v[136:139], v[56:59], v[8:11]
    v_mfma_f32_16x16x32_bf16 v[12:15], v[140:143], v[56:59], v[12:15]
    buffer_load_dwordx4 v[56:59], v244, s[20:23], s84 offen offset:1024 sc1
    v_mfma_f32_16x16x32_bf16 v[28:31], v[140:143], v[60:63], v[28:31]
    v_mfma_f32_16x16x32_bf16 v[24:27], v[136:139], v[60:63], v[24:27]
    v_mfma_f32_16x16x32_bf16 v[20:23], v[132:135], v[60:63], v[20:23]
    v_mfma_f32_16x16x32_bf16 v[16:19], v[128:131], v[60:63], v[16:19]
    buffer_load_dwordx4 v[60:63], v245, s[20:23], s84 offen offset:1024 sc1
    s_waitcnt vmcnt(10)
    v_mfma_f32_16x16x32_bf16 v[0:3], v[144:147], v[64:67], v[0:3]
    v_mfma_f32_16x16x32_bf16 v[4:7], v[148:151], v[64:67], v[4:7]
    v_mfma_f32_16x16x32_bf16 v[8:11], v[152:155], v[64:67], v[8:11]
    v_mfma_f32_16x16x32_bf16 v[12:15], v[156:159], v[64:67], v[12:15]
    buffer_load_dwordx4 v[64:67], v244, s[20:23], s85 offen offset:0 sc1
    v_mfma_f32_16x16x32_bf16 v[28:31], v[156:159], v[68:71], v[28:31]
    v_mfma_f32_16x16x32_bf16 v[24:27], v[152:155], v[68:71], v[24:27]
    v_mfma_f32_16x16x32_bf16 v[20:23], v[148:151], v[68:71], v[20:23]
    v_mfma_f32_16x16x32_bf16 v[16:19], v[144:147], v[68:71], v[16:19]
    buffer_load_dwordx4 v[68:71], v245, s[20:23], s85 offen offset:0 sc1
    s_waitcnt vmcnt(10)
    v_mfma_f32_16x16x32_bf16 v[0:3], v[160:163], v[72:75], v[0:3]
    v_mfma_f32_16x16x32_bf16 v[4:7], v[164:167], v[72:75], v[4:7]
    v_mfma_f32_16x16x32_bf16 v[8:11], v[168:171], v[72:75], v[8:11]
    v_mfma_f32_16x16x32_bf16 v[12:15], v[172:175], v[72:75], v[12:15]
    buffer_load_dwordx4 v[72:75], v244, s[20:23], s85 offen offset:1024 sc1
    v_mfma_f32_16x16x32_bf16 v[28:31], v[172:175], v[76:79], v[28:31]
    v_mfma_f32_16x16x32_bf16 v[24:27], v[168:171], v[76:79], v[24:27]
    v_mfma_f32_16x16x32_bf16 v[20:23], v[164:167], v[76:79], v[20:23]
    v_mfma_f32_16x16x32_bf16 v[16:19], v[160:163], v[76:79], v[16:19]
    buffer_load_dwordx4 v[76:79], v245, s[20:23], s85 offen offset:1024 sc1
    s_waitcnt vmcnt(10)
    v_mfma_f32_16x16x32_bf16 v[0:3], v[176:179], v[32:35], v[0:3]
    v_mfma_f32_16x16x32_bf16 v[4:7], v[180:183], v[32:35], v[4:7]
    v_mfma_f32_16x16x32_bf16 v[8:11], v[184:187], v[32:35], v[8:11]
    v_mfma_f32_16x16x32_bf16 v[12:15], v[188:191], v[32:35], v[12:15]
    buffer_load_dwordx4 v[32:35], v244, s[20:23], s86 offen offset:0 sc1
    v_mfma_f32_16x16x32_bf16 v[28:31], v[188:191], v[36:39], v[28:31]
    v_mfma_f32_16x16x32_bf16 v[24:27], v[184:187], v[36:39], v[24:27]
    v_mfma_f32_16x16x32_bf16 v[20:23], v[180:183], v[36:39], v[20:23]
    v_mfma_f32_16x16x32_bf16 v[16:19], v[176:179], v[36:39], v[16:19]
    buffer_load_dwordx4 v[36:39], v245, s[20:23], s86 offen offset:0 sc1
    s_waitcnt vmcnt(10)
    v_mfma_f32_16x16x32_bf16 v[0:3], v[192:195], v[40:43], v[0:3]
    ds_read_b64_tr_b16 v[80:81], v236 offset:0
    v_mfma_f32_16x16x32_bf16 v[4:7], v[196:199], v[40:43], v[4:7]
    ds_read_b64_tr_b16 v[82:83], v236 offset:2048
    v_mfma_f32_16x16x32_bf16 v[8:11], v[200:203], v[40:43], v[8:11]
    ds_read_b64_tr_b16 v[84:85], v237 offset:0
    v_mfma_f32_16x16x32_bf16 v[12:15], v[204:207], v[40:43], v[12:15]
    ds_read_b64_tr_b16 v[86:87], v237 offset:2048
    buffer_load_dwordx4 v[40:43], v244, s[20:23], s86 offen offset:1024 sc1
    v_mfma_f32_16x16x32_bf16 v[28:31], v[204:207], v[44:47], v[28:31]
    ds_read_b64_tr_b16 v[88:89], v238 offset:0
    v_mfma_f32_16x16x32_bf16 v[24:27], v[200:203], v[44:47], v[24:27]
    ds_read_b64_tr_b16 v[90:91], v238 offset:2048
    v_mfma_f32_16x16x32_bf16 v[20:23], v[196:199], v[44:47], v[20:23]
    ds_read_b64_tr_b16 v[92:93], v239 offset:0
    v_mfma_f32_16x16x32_bf16 v[16:19], v[192:195], v[44:47], v[16:19]
    ds_read_b64_tr_b16 v[94:95], v239 offset:2048
    buffer_load_dwordx4 v[44:47], v245, s[20:23], s86 offen offset:1024 sc1
    s_waitcnt vmcnt(10)
    v_mfma_f32_16x16x32_bf16 v[0:3], v[208:211], v[48:51], v[0:3]
    ds_read_b64_tr_b16 v[96:97], v236 offset:8192
    v_mfma_f32_16x16x32_bf16 v[4:7], v[212:215], v[48:51], v[4:7]
    ds_read_b64_tr_b16 v[98:99], v236 offset:10240
    v_mfma_f32_16x16x32_bf16 v[8:11], v[216:219], v[48:51], v[8:11]
    ds_read_b64_tr_b16 v[100:101], v237 offset:8192
    v_mfma_f32_16x16x32_bf16 v[12:15], v[220:223], v[48:51], v[12:15]
    ds_read_b64_tr_b16 v[102:103], v237 offset:10240
    v_mfma_f32_16x16x32_bf16 v[28:31], v[220:223], v[52:55], v[28:31]
    ds_read_b64_tr_b16 v[104:105], v238 offset:8192
    v_mfma_f32_16x16x32_bf16 v[24:27], v[216:219], v[52:55], v[24:27]
    ds_read_b64_tr_b16 v[106:107], v238 offset:10240
    v_mfma_f32_16x16x32_bf16 v[20:23], v[212:215], v[52:55], v[20:23]
    ds_read_b64_tr_b16 v[108:109], v239 offset:8192
    v_mfma_f32_16x16x32_bf16 v[16:19], v[208:211], v[52:55], v[16:19]
    ds_read_b64_tr_b16 v[110:111], v239 offset:10240
    s_waitcnt vmcnt(8) lgkmcnt(8)
    s_barrier
    v_xor_b32 v244, 4096, v244
    v_xor_b32 v245, 4096, v245
    buffer_load_dwordx4 v[48:51], v244, s[20:23], s80 offen offset:0 sc1
    buffer_load_dwordx4 v[52:55], v245, s[20:23], s80 offen offset:0 sc1
    v_mfma_f32_16x16x32_bf16 v[0:3], v[80:83], v[56:59], v[0:3]
    ds_read_b64_tr_b16 v[112:113], v236 offset:16384
    v_mfma_f32_16x16x32_bf16 v[4:7], v[84:87], v[56:59], v[4:7]
    ds_read_b64_tr_b16 v[114:115], v236 offset:18432
    v_mfma_f32_16x16x32_bf16 v[8:11], v[88:91], v[56:59], v[8:11]
    ds_read_b64_tr_b16 v[116:117], v237 offset:16384
    v_mfma_f32_16x16x32_bf16 v[12:15], v[92:95], v[56:59], v[12:15]
    ds_read_b64_tr_b16 v[118:119], v237 offset:18432
    buffer_load_dwordx4 v[56:59], v244, s[20:23], s80 offen offset:1024 sc1
    v_mfma_f32_16x16x32_bf16 v[28:31], v[92:95], v[60:63], v[28:31]
    ds_read_b64_tr_b16 v[120:121], v238 offset:16384
    v_mfma_f32_16x16x32_bf16 v[24:27], v[88:91], v[60:63], v[24:27]
    ds_read_b64_tr_b16 v[122:123], v238 offset:18432
    v_mfma_f32_16x16x32_bf16 v[20:23], v[84:87], v[60:63], v[20:23]
    ds_read_b64_tr_b16 v[124:125], v239 offset:16384
    v_mfma_f32_16x16x32_bf16 v[16:19], v[80:83], v[60:63], v[16:19]
    ds_read_b64_tr_b16 v[126:127], v239 offset:18432
    buffer_load_dwordx4 v[60:63], v245, s[20:23], s80 offen offset:1024 sc1
    s_waitcnt vmcnt(10) lgkmcnt(8)
    v_mfma_f32_16x16x32_bf16 v[0:3], v[96:99], v[64:67], v[0:3]
    ds_read_b64_tr_b16 v[128:129], v236 offset:24576
    v_mfma_f32_16x16x32_bf16 v[4:7], v[100:103], v[64:67], v[4:7]
    ds_read_b64_tr_b16 v[130:131], v236 offset:26624
    v_mfma_f32_16x16x32_bf16 v[8:11], v[104:107], v[64:67], v[8:11]
    ds_read_b64_tr_b16 v[132:133], v237 offset:24576
    v_mfma_f32_16x16x32_bf16 v[12:15], v[108:111], v[64:67], v[12:15]
    ds_read_b64_tr_b16 v[134:135], v237 offset:26624
    buffer_load_dwordx4 v[64:67], v244, s[20:23], s81 offen offset:0 sc1
    v_mfma_f32_16x16x32_bf16 v[28:31], v[108:111], v[68:71], v[28:31]
    ds_read_b64_tr_b16 v[136:137], v238 offset:24576
    v_mfma_f32_16x16x32_bf16 v[24:27], v[104:107], v[68:71], v[24:27]
    ds_read_b64_tr_b16 v[138:139], v238 offset:26624
    v_mfma_f32_16x16x32_bf16 v[20:23], v[100:103], v[68:71], v[20:23]
    ds_read_b64_tr_b16 v[140:141], v239 offset:24576
    v_mfma_f32_16x16x32_bf16 v[16:19], v[96:99], v[68:71], v[16:19]
    ds_read_b64_tr_b16 v[142:143], v239 offset:26624
    buffer_load_dwordx4 v[68:71], v245, s[20:23], s81 offen offset:0 sc1
    s_waitcnt vmcnt(10) lgkmcnt(8)
    v_mfma_f32_16x16x32_bf16 v[0:3], v[112:115], v[72:75], v[0:3]
    ds_read_b64_tr_b16 v[144:145], v232 offset:0
    v_mfma_f32_16x16x32_bf16 v[4:7], v[116:119], v[72:75], v[4:7]
    ds_read_b64_tr_b16 v[146:147], v232 offset:2048
    v_mfma_f32_16x16x32_bf16 v[8:11], v[120:123], v[72:75], v[8:11]
    ds_read_b64_tr_b16 v[148:149], v233 offset:0
    v_mfma_f32_16x16x32_bf16 v[12:15], v[124:127], v[72:75], v[12:15]
    ds_read_b64_tr_b16 v[150:151], v233 offset:2048
    buffer_load_dwordx4 v[72:75], v244, s[20:23], s81 offen offset:1024 sc1
    v_mfma_f32_16x16x32_bf16 v[28:31], v[124:127], v[76:79], v[28:31]
    ds_read_b64_tr_b16 v[152:153], v234 offset:0
    v_mfma_f32_16x16x32_bf16 v[24:27], v[120:123], v[76:79], v[24:27]
    ds_read_b64_tr_b16 v[154:155], v234 offset:2048
    v_mfma_f32_16x16x32_bf16 v[20:23], v[116:119], v[76:79], v[20:23]
    ds_read_b64_tr_b16 v[156:157], v235 offset:0
    v_mfma_f32_16x16x32_bf16 v[16:19], v[112:115], v[76:79], v[16:19]
    ds_read_b64_tr_b16 v[158:159], v235 offset:2048
    buffer_load_dwordx4 v[76:79], v245, s[20:23], s81 offen offset:1024 sc1
    s_waitcnt vmcnt(10) lgkmcnt(8)
    v_mfma_f32_16x16x32_bf16 v[0:3], v[128:131], v[32:35], v[0:3]
    ds_read_b64_tr_b16 v[160:161], v232 offset:8192
    v_mfma_f32_16x16x32_bf16 v[4:7], v[132:135], v[32:35], v[4:7]
    ds_read_b64_tr_b16 v[162:163], v232 offset:10240
    v_mfma_f32_16x16x32_bf16 v[8:11], v[136:139], v[32:35], v[8:11]
    ds_read_b64_tr_b16 v[164:165], v233 offset:8192
    v_mfma_f32_16x16x32_bf16 v[12:15], v[140:143], v[32:35], v[12:15]
    ds_read_b64_tr_b16 v[166:167], v233 offset:10240
    buffer_load_dwordx4 v[32:35], v244, s[20:23], s82 offen offset:0 sc1
    v_mfma_f32_16x16x32_bf16 v[28:31], v[140:143], v[36:39], v[28:31]
    ds_read_b64_tr_b16 v[168:169], v234 offset:8192
    v_mfma_f32_16x16x32_bf16 v[24:27], v[136:139], v[36:39], v[24:27]
    ds_read_b64_tr_b16 v[170:171], v234 offset:10240
    v_mfma_f32_16x16x32_bf16 v[20:23], v[132:135], v[36:39], v[20:23]
    ds_read_b64_tr_b16 v[172:173], v235 offset:8192
    v_mfma_f32_16x16x32_bf16 v[16:19], v[128:131], v[36:39], v[16:19]
    ds_read_b64_tr_b16 v[174:175], v235 offset:10240
    buffer_load_dwordx4 v[36:39], v245, s[20:23], s82 offen offset:0 sc1
    s_waitcnt vmcnt(10) lgkmcnt(8)
    v_mfma_f32_16x16x32_bf16 v[0:3], v[144:147], v[40:43], v[0:3]
    ds_read_b64_tr_b16 v[176:177], v232 offset:16384
    v_mfma_f32_16x16x32_bf16 v[4:7], v[148:151], v[40:43], v[4:7]
    ds_read_b64_tr_b16 v[178:179], v232 offset:18432
    v_mfma_f32_16x16x32_bf16 v[8:11], v[152:155], v[40:43], v[8:11]
    ds_read_b64_tr_b16 v[180:181], v233 offset:16384
    v_mfma_f32_16x16x32_bf16 v[12:15], v[156:159], v[40:43], v[12:15]
    ds_read_b64_tr_b16 v[182:183], v233 offset:18432
    buffer_load_dwordx4 v[40:43], v244, s[20:23], s82 offen offset:1024 sc1
    v_mfma_f32_16x16x32_bf16 v[28:31], v[156:159], v[44:47], v[28:31]
    ds_read_b64_tr_b16 v[184:185], v234 offset:16384
    v_mfma_f32_16x16x32_bf16 v[24:27], v[152:155], v[44:47], v[24:27]
    ds_read_b64_tr_b16 v[186:187], v234 offset:18432
    v_mfma_f32_16x16x32_bf16 v[20:23], v[148:151], v[44:47], v[20:23]
    ds_read_b64_tr_b16 v[188:189], v235 offset:16384
    v_mfma_f32_16x16x32_bf16 v[16:19], v[144:147], v[44:47], v[16:19]
    ds_read_b64_tr_b16 v[190:191], v235 offset:18432
    buffer_load_dwordx4 v[44:47], v245, s[20:23], s82 offen offset:1024 sc1
    s_waitcnt vmcnt(10) lgkmcnt(8)
    s_barrier
    v_mfma_f32_16x16x32_bf16 v[0:3], v[160:163], v[48:51], v[0:3]
    ds_read_b64_tr_b16 v[192:193], v232 offset:24576
    v_mfma_f32_16x16x32_bf16 v[4:7], v[164:167], v[48:51], v[4:7]
    ds_read_b64_tr_b16 v[194:195], v232 offset:26624
    v_mfma_f32_16x16x32_bf16 v[8:11], v[168:171], v[48:51], v[8:11]
    ds_read_b64_tr_b16 v[196:197], v233 offset:24576
    v_mfma_f32_16x16x32_bf16 v[12:15], v[172:175], v[48:51], v[12:15]
    ds_read_b64_tr_b16 v[198:199], v233 offset:26624
    buffer_load_dwordx4 v[48:51], v244, s[20:23], s83 offen offset:0 sc1
    v_mfma_f32_16x16x32_bf16 v[28:31], v[172:175], v[52:55], v[28:31]
    ds_read_b64_tr_b16 v[200:201], v234 offset:24576
    v_mfma_f32_16x16x32_bf16 v[24:27], v[168:171], v[52:55], v[24:27]
    ds_read_b64_tr_b16 v[202:203], v234 offset:26624
    v_mfma_f32_16x16x32_bf16 v[20:23], v[164:167], v[52:55], v[20:23]
    ds_read_b64_tr_b16 v[204:205], v235 offset:24576
    v_mfma_f32_16x16x32_bf16 v[16:19], v[160:163], v[52:55], v[16:19]
    ds_read_b64_tr_b16 v[206:207], v235 offset:26624
    buffer_load_dwordx4 v[52:55], v245, s[20:23], s83 offen offset:0 sc1
    s_waitcnt vmcnt(10) lgkmcnt(8)
    v_mfma_f32_16x16x32_bf16 v[0:3], v[176:179], v[56:59], v[0:3]
    ds_read_b64_tr_b16 v[208:209], v232 offset:32768
    v_mfma_f32_16x16x32_bf16 v[4:7], v[180:183], v[56:59], v[4:7]
    ds_read_b64_tr_b16 v[210:211], v232 offset:34816
    v_mfma_f32_16x16x32_bf16 v[8:11], v[184:187], v[56:59], v[8:11]
    ds_read_b64_tr_b16 v[212:213], v233 offset:32768
    v_mfma_f32_16x16x32_bf16 v[12:15], v[188:191], v[56:59], v[12:15]
    ds_read_b64_tr_b16 v[214:215], v233 offset:34816
    buffer_load_dwordx4 v[56:59], v244, s[20:23], s83 offen offset:1024 sc1
    v_mfma_f32_16x16x32_bf16 v[28:31], v[188:191], v[60:63], v[28:31]
    ds_read_b64_tr_b16 v[216:217], v234 offset:32768
    v_mfma_f32_16x16x32_bf16 v[24:27], v[184:187], v[60:63], v[24:27]
    ds_read_b64_tr_b16 v[218:219], v234 offset:34816
    v_mfma_f32_16x16x32_bf16 v[20:23], v[180:183], v[60:63], v[20:23]
    ds_read_b64_tr_b16 v[220:221], v235 offset:32768
    v_mfma_f32_16x16x32_bf16 v[16:19], v[176:179], v[60:63], v[16:19]
    ds_read_b64_tr_b16 v[222:223], v235 offset:34816
    buffer_load_dwordx4 v[60:63], v245, s[20:23], s83 offen offset:1024 sc1
    s_waitcnt vmcnt(10) lgkmcnt(8)
    v_mfma_f32_16x16x32_bf16 v[0:3], v[192:195], v[64:67], v[0:3]
    ds_read_b64_tr_b16 v[80:81], v232 offset:40960
    v_mfma_f32_16x16x32_bf16 v[4:7], v[196:199], v[64:67], v[4:7]
    ds_read_b64_tr_b16 v[82:83], v232 offset:43008
    v_mfma_f32_16x16x32_bf16 v[8:11], v[200:203], v[64:67], v[8:11]
    ds_read_b64_tr_b16 v[84:85], v233 offset:40960
    v_mfma_f32_16x16x32_bf16 v[12:15], v[204:207], v[64:67], v[12:15]
    ds_read_b64_tr_b16 v[86:87], v233 offset:43008
    buffer_load_dwordx4 v[64:67], v244, s[20:23], s84 offen offset:0 sc1
    v_mfma_f32_16x16x32_bf16 v[28:31], v[204:207], v[68:71], v[28:31]
    ds_read_b64_tr_b16 v[88:89], v234 offset:40960
    v_mfma_f32_16x16x32_bf16 v[24:27], v[200:203], v[68:71], v[24:27]
    ds_read_b64_tr_b16 v[90:91], v234 offset:43008
    v_mfma_f32_16x16x32_bf16 v[20:23], v[196:199], v[68:71], v[20:23]
    ds_read_b64_tr_b16 v[92:93], v235 offset:40960
    v_mfma_f32_16x16x32_bf16 v[16:19], v[192:195], v[68:71], v[16:19]
    ds_read_b64_tr_b16 v[94:95], v235 offset:43008
    buffer_load_dwordx4 v[68:71], v245, s[20:23], s84 offen offset:0 sc1
    s_waitcnt vmcnt(10) lgkmcnt(8)
    v_mfma_f32_16x16x32_bf16 v[0:3], v[208:211], v[72:75], v[0:3]
    ds_read_b64_tr_b16 v[96:97], v236 offset:32768
    v_mfma_f32_16x16x32_bf16 v[4:7], v[212:215], v[72:75], v[4:7]
    ds_read_b64_tr_b16 v[98:99], v236 offset:34816
    v_mfma_f32_16x16x32_bf16 v[8:11], v[216:219], v[72:75], v[8:11]
    ds_read_b64_tr_b16 v[100:101], v237 offset:32768
    v_mfma_f32_16x16x32_bf16 v[12:15], v[220:223], v[72:75], v[12:15]
    ds_read_b64_tr_b16 v[102:103], v237 offset:34816
    buffer_load_dwordx4 v[72:75], v244, s[20:23], s84 offen offset:1024 sc1
    v_mfma_f32_16x16x32_bf16 v[28:31], v[220:223], v[76:79], v[28:31]
    ds_read_b64_tr_b16 v[104:105], v238 offset:32768
    v_mfma_f32_16x16x32_bf16 v[24:27], v[216:219], v[76:79], v[24:27]
    ds_read_b64_tr_b16 v[106:107], v238 offset:34816
    v_mfma_f32_16x16x32_bf16 v[20:23], v[212:215], v[76:79], v[20:23]
    ds_read_b64_tr_b16 v[108:109], v239 offset:32768
    v_mfma_f32_16x16x32_bf16 v[16:19], v[208:211], v[76:79], v[16:19]
    ds_read_b64_tr_b16 v[110:111], v239 offset:34816
    buffer_load_dwordx4 v[76:79], v245, s[20:23], s84 offen offset:1024 sc1
    s_waitcnt vmcnt(10) lgkmcnt(8)
    v_mfma_f32_16x16x32_bf16 v[0:3], v[80:83], v[32:35], v[0:3]
    ds_read_b64_tr_b16 v[112:113], v236 offset:40960
    v_mfma_f32_16x16x32_bf16 v[4:7], v[84:87], v[32:35], v[4:7]
    ds_read_b64_tr_b16 v[114:115], v236 offset:43008
    v_mfma_f32_16x16x32_bf16 v[8:11], v[88:91], v[32:35], v[8:11]
    ds_read_b64_tr_b16 v[116:117], v237 offset:40960
    v_mfma_f32_16x16x32_bf16 v[12:15], v[92:95], v[32:35], v[12:15]
    ds_read_b64_tr_b16 v[118:119], v237 offset:43008
    buffer_load_dwordx4 v[32:35], v244, s[20:23], s85 offen offset:0 sc1
    v_mfma_f32_16x16x32_bf16 v[28:31], v[92:95], v[36:39], v[28:31]
    ds_read_b64_tr_b16 v[120:121], v238 offset:40960
    v_mfma_f32_16x16x32_bf16 v[24:27], v[88:91], v[36:39], v[24:27]
    ds_read_b64_tr_b16 v[122:123], v238 offset:43008
    v_mfma_f32_16x16x32_bf16 v[20:23], v[84:87], v[36:39], v[20:23]
    ds_read_b64_tr_b16 v[124:125], v239 offset:40960
    v_mfma_f32_16x16x32_bf16 v[16:19], v[80:83], v[36:39], v[16:19]
    ds_read_b64_tr_b16 v[126:127], v239 offset:43008
    buffer_load_dwordx4 v[36:39], v245, s[20:23], s85 offen offset:0 sc1
    s_waitcnt vmcnt(10) lgkmcnt(8)
    ds_read_b64 v[224:225], v247 offset:0
    ds_read_b64 v[226:227], v248 offset:0
    ds_read_b64 v[228:229], v247 offset:2048
    ds_read_b64 v[230:231], v248 offset:2048
    v_mfma_f32_16x16x32_bf16 v[0:3], v[96:99], v[40:43], v[0:3]
    ds_read_b64_tr_b16 v[128:129], v236 offset:49152
    v_mfma_f32_16x16x32_bf16 v[4:7], v[100:103], v[40:43], v[4:7]
    ds_read_b64_tr_b16 v[130:131], v236 offset:51200
    v_mfma_f32_16x16x32_bf16 v[8:11], v[104:107], v[40:43], v[8:11]
    ds_read_b64_tr_b16 v[132:133], v237 offset:49152
    v_mfma_f32_16x16x32_bf16 v[12:15], v[108:111], v[40:43], v[12:15]
    ds_read_b64_tr_b16 v[134:135], v237 offset:51200
    buffer_load_dwordx4 v[40:43], v244, s[20:23], s85 offen offset:1024 sc1
    v_mfma_f32_16x16x32_bf16 v[28:31], v[108:111], v[44:47], v[28:31]
    ds_read_b64_tr_b16 v[136:137], v238 offset:49152
    v_mfma_f32_16x16x32_bf16 v[24:27], v[104:107], v[44:47], v[24:27]
    ds_read_b64_tr_b16 v[138:139], v238 offset:51200
    v_mfma_f32_16x16x32_bf16 v[20:23], v[100:103], v[44:47], v[20:23]
    ds_read_b64_tr_b16 v[140:141], v239 offset:49152
    v_mfma_f32_16x16x32_bf16 v[16:19], v[96:99], v[44:47], v[16:19]
    ds_read_b64_tr_b16 v[142:143], v239 offset:51200
    buffer_load_dwordx4 v[44:47], v245, s[20:23], s85 offen offset:1024 sc1
    s_waitcnt vmcnt(10) lgkmcnt(8)
    v_mfma_f32_16x16x32_bf16 v[0:3], v[112:115], v[48:51], v[0:3]
    ds_read_b64_tr_b16 v[144:145], v236 offset:57344
    v_mfma_f32_16x16x32_bf16 v[4:7], v[116:119], v[48:51], v[4:7]
    ds_read_b64_tr_b16 v[146:147], v236 offset:59392
    v_mfma_f32_16x16x32_bf16 v[8:11], v[120:123], v[48:51], v[8:11]
    ds_read_b64_tr_b16 v[148:149], v237 offset:57344
    v_mfma_f32_16x16x32_bf16 v[12:15], v[124:127], v[48:51], v[12:15]
    ds_read_b64_tr_b16 v[150:151], v237 offset:59392
    buffer_load_dwordx4 v[48:51], v244, s[20:23], s86 offen offset:0 sc1
    v_mfma_f32_16x16x32_bf16 v[28:31], v[124:127], v[52:55], v[28:31]
    ds_read_b64_tr_b16 v[152:153], v238 offset:57344
    v_mfma_f32_16x16x32_bf16 v[24:27], v[120:123], v[52:55], v[24:27]
    ds_read_b64_tr_b16 v[154:155], v238 offset:59392
    v_mfma_f32_16x16x32_bf16 v[20:23], v[116:119], v[52:55], v[20:23]
    ds_read_b64_tr_b16 v[156:157], v239 offset:57344
    v_mfma_f32_16x16x32_bf16 v[16:19], v[112:115], v[52:55], v[16:19]
    ds_read_b64_tr_b16 v[158:159], v239 offset:59392
    buffer_load_dwordx4 v[52:55], v245, s[20:23], s86 offen offset:0 sc1
    s_waitcnt vmcnt(10) lgkmcnt(8)
    v_mfma_f32_16x16x32_bf16 v[0:3], v[128:131], v[56:59], v[0:3]
    ds_read_b64_tr_b16 v[160:161], v240 offset:0
    v_lshlrev_b32 v112, 16, v224
    v_mfma_f32_16x16x32_bf16 v[4:7], v[132:135], v[56:59], v[4:7]
    ds_read_b64_tr_b16 v[162:163], v240 offset:2048
    v_and_b32 v113, 0xffff0000, v224
    v_mfma_f32_16x16x32_bf16 v[8:11], v[136:139], v[56:59], v[8:11]
    ds_read_b64_tr_b16 v[164:165], v241 offset:0
    v_lshlrev_b32 v114, 16, v225
    v_mfma_f32_16x16x32_bf16 v[12:15], v[140:143], v[56:59], v[12:15]
    ds_read_b64_tr_b16 v[166:167], v241 offset:2048
    buffer_load_dwordx4 v[56:59], v244, s[20:23], s86 offen offset:1024 sc1
    v_and_b32 v115, 0xffff0000, v225
    v_mfma_f32_16x16x32_bf16 v[28:31], v[140:143], v[60:63], v[28:31]
    ds_read_b64_tr_b16 v[168:169], v242 offset:0
    v_lshlrev_b32 v116, 16, v226
    v_mfma_f32_16x16x32_bf16 v[24:27], v[136:139], v[60:63], v[24:27]
    ds_read_b64_tr_b16 v[170:171], v242 offset:2048
    v_and_b32 v117, 0xffff0000, v226
    v_mfma_f32_16x16x32_bf16 v[20:23], v[132:135], v[60:63], v[20:23]
    ds_read_b64_tr_b16 v[172:173], v243 offset:0
    v_lshlrev_b32 v118, 16, v227
    v_mfma_f32_16x16x32_bf16 v[16:19], v[128:131], v[60:63], v[16:19]
    ds_read_b64_tr_b16 v[174:175], v243 offset:2048
    buffer_load_dwordx4 v[60:63], v245, s[20:23], s86 offen offset:1024 sc1
    v_and_b32 v119, 0xffff0000, v227
    s_waitcnt vmcnt(10) lgkmcnt(8)
    v_mfma_f32_16x16x32_bf16 v[0:3], v[144:147], v[64:67], v[0:3]
    ds_read_b64_tr_b16 v[176:177], v240 offset:8192
    v_lshlrev_b32 v120, 16, v228
    v_mfma_f32_16x16x32_bf16 v[4:7], v[148:151], v[64:67], v[4:7]
    ds_read_b64_tr_b16 v[178:179], v240 offset:10240
    v_and_b32 v121, 0xffff0000, v228
    v_mfma_f32_16x16x32_bf16 v[8:11], v[152:155], v[64:67], v[8:11]
    ds_read_b64_tr_b16 v[180:181], v241 offset:8192
    v_lshlrev_b32 v122, 16, v229
    v_mfma_f32_16x16x32_bf16 v[12:15], v[156:159], v[64:67], v[12:15]
    ds_read_b64_tr_b16 v[182:183], v241 offset:10240
    v_and_b32 v123, 0xffff0000, v229
    v_mfma_f32_16x16x32_bf16 v[28:31], v[156:159], v[68:71], v[28:31]
    ds_read_b64_tr_b16 v[184:185], v242 offset:8192
    v_lshlrev_b32 v124, 16, v230
    v_mfma_f32_16x16x32_bf16 v[24:27], v[152:155], v[68:71], v[24:27]
    ds_read_b64_tr_b16 v[186:187], v242 offset:10240
    v_and_b32 v125, 0xffff0000, v230
    v_mfma_f32_16x16x32_bf16 v[20:23], v[148:151], v[68:71], v[20:23]
    ds_read_b64_tr_b16 v[188:189], v243 offset:8192
    v_lshlrev_b32 v126, 16, v231
    v_mfma_f32_16x16x32_bf16 v[16:19], v[144:147], v[68:71], v[16:19]
    ds_read_b64_tr_b16 v[190:191], v243 offset:10240
    v_and_b32 v127, 0xffff0000, v231
    s_waitcnt vmcnt(8) lgkmcnt(8)
    v_mfma_f32_16x16x32_bf16 v[0:3], v[160:163], v[72:75], v[0:3]
    ds_read_b64_tr_b16 v[192:193], v240 offset:16384
    v_lshlrev_b32 v249, 4, v255
    v_mfma_f32_16x16x32_bf16 v[4:7], v[164:167], v[72:75], v[4:7]
    ds_read_b64_tr_b16 v[194:195], v240 offset:18432
    s_lshl_b32 s62, s56, 12
    v_mfma_f32_16x16x32_bf16 v[8:11], v[168:171], v[72:75], v[8:11]
    ds_read_b64_tr_b16 v[196:197], v241 offset:16384
    s_add_u32 s62, s62, 81920
    v_mfma_f32_16x16x32_bf16 v[12:15], v[172:175], v[72:75], v[12:15]
    ds_read_b64_tr_b16 v[198:199], v241 offset:18432
    v_add_u32 v250, s62, v249
    v_mfma_f32_16x16x32_bf16 v[28:31], v[172:175], v[76:79], v[28:31]
    ds_read_b64_tr_b16 v[200:201], v242 offset:16384
    v_xor_b32 v251, 8192, v250
    v_mfma_f32_16x16x32_bf16 v[24:27], v[168:171], v[76:79], v[24:27]
    ds_read_b64_tr_b16 v[202:203], v242 offset:18432
    s_lshl2_add_u32 s62, s74, s75
    v_mfma_f32_16x16x32_bf16 v[20:23], v[164:167], v[76:79], v[20:23]
    ds_read_b64_tr_b16 v[204:205], v243 offset:16384
    s_lshl_b32 s62, s62, 11
    v_mfma_f32_16x16x32_bf16 v[16:19], v[160:163], v[76:79], v[16:19]
    ds_read_b64_tr_b16 v[206:207], v243 offset:18432
    s_add_u32 s62, s62, 65536
    s_waitcnt vmcnt(6) lgkmcnt(8)
    v_mfma_f32_16x16x32_bf16 v[0:3], v[176:179], v[32:35], v[0:3]
    ds_read_b64_tr_b16 v[208:209], v232 offset:49152
    v_add_u32 v252, s62, v249
    v_mfma_f32_16x16x32_bf16 v[4:7], v[180:183], v[32:35], v[4:7]
    ds_read_b64_tr_b16 v[210:211], v232 offset:51200
    s_mov_b32 s64, 0xbfb8aa3b
    v_mfma_f32_16x16x32_bf16 v[8:11], v[184:187], v[32:35], v[8:11]
    ds_read_b64_tr_b16 v[212:213], v233 offset:49152
    s_mov_b32 s65, s64
    v_mfma_f32_16x16x32_bf16 v[12:15], v[188:191], v[32:35], v[12:15]
    ds_read_b64_tr_b16 v[214:215], v233 offset:51200
    v_mfma_f32_16x16x32_bf16 v[28:31], v[188:191], v[36:39], v[28:31]
    ds_read_b64_tr_b16 v[216:217], v234 offset:49152
    v_mfma_f32_16x16x32_bf16 v[24:27], v[184:187], v[36:39], v[24:27]
    ds_read_b64_tr_b16 v[218:219], v234 offset:51200
    v_mfma_f32_16x16x32_bf16 v[20:23], v[180:183], v[36:39], v[20:23]
    ds_read_b64_tr_b16 v[220:221], v235 offset:49152
    v_mfma_f32_16x16x32_bf16 v[16:19], v[176:179], v[36:39], v[16:19]
    ds_read_b64_tr_b16 v[222:223], v235 offset:51200
    s_waitcnt vmcnt(4) lgkmcnt(8)
    v_mfma_f32_16x16x32_bf16 v[8:11], v[200:203], v[40:43], v[8:11]
    ds_read_b64_tr_b16 v[80:81], v232 offset:57344
    ds_read_b64_tr_b16 v[82:83], v232 offset:59392
    v_mfma_f32_16x16x32_bf16 v[12:15], v[204:207], v[40:43], v[12:15]
    ds_read_b64_tr_b16 v[84:85], v233 offset:57344
    ds_read_b64_tr_b16 v[86:87], v233 offset:59392
    v_mfma_f32_16x16x32_bf16 v[28:31], v[204:207], v[44:47], v[28:31]
    ds_read_b64_tr_b16 v[88:89], v234 offset:57344
    ds_read_b64_tr_b16 v[90:91], v234 offset:59392
    v_mfma_f32_16x16x32_bf16 v[24:27], v[200:203], v[44:47], v[24:27]
    ds_read_b64_tr_b16 v[92:93], v235 offset:57344
    ds_read_b64_tr_b16 v[94:95], v235 offset:59392
    s_waitcnt vmcnt(2) lgkmcnt(8)
    v_mfma_f32_16x16x32_bf16 v[8:11], v[216:219], v[48:51], v[8:11]
    v_mfma_f32_16x16x32_bf16 v[12:15], v[220:223], v[48:51], v[12:15]
    v_mfma_f32_16x16x32_bf16 v[28:31], v[220:223], v[52:55], v[28:31]
    v_mfma_f32_16x16x32_bf16 v[24:27], v[216:219], v[52:55], v[24:27]
    s_waitcnt vmcnt(0) lgkmcnt(0)
    v_mfma_f32_16x16x32_bf16 v[8:11], v[88:91], v[56:59], v[8:11]
    v_mfma_f32_16x16x32_bf16 v[12:15], v[92:95], v[56:59], v[12:15]
    v_mfma_f32_16x16x32_bf16 v[28:31], v[92:95], v[60:63], v[28:31]
    v_mfma_f32_16x16x32_bf16 v[24:27], v[88:91], v[60:63], v[24:27]
    v_mfma_f32_16x16x32_bf16 v[0:3], v[192:195], v[40:43], v[0:3]
    v_mfma_f32_16x16x32_bf16 v[4:7], v[196:199], v[40:43], v[4:7]
    v_mfma_f32_16x16x32_bf16 v[20:23], v[196:199], v[44:47], v[20:23]
    v_mfma_f32_16x16x32_bf16 v[16:19], v[192:195], v[44:47], v[16:19]
    s_nop 0
    ds_write_b128 v250, v[8:11] offset:0
    v_mfma_f32_16x16x32_bf16 v[0:3], v[208:211], v[48:51], v[0:3]
    ds_write_b128 v250, v[12:15] offset:1024
    v_mfma_f32_16x16x32_bf16 v[4:7], v[212:215], v[48:51], v[4:7]
    ds_write_b128 v250, v[28:31] offset:3072
    v_mfma_f32_16x16x32_bf16 v[20:23], v[212:215], v[52:55], v[20:23]
    ds_write_b128 v250, v[24:27] offset:2048
    v_mfma_f32_16x16x32_bf16 v[16:19], v[208:211], v[52:55], v[16:19]
    s_waitcnt lgkmcnt(0)
    s_barrier
    ds_read_b128 v[128:131], v251 offset:0
    ds_read_b128 v[132:135], v251 offset:1024
    ds_read_b128 v[144:147], v252 offset:0
    ds_read_b128 v[148:151], v252 offset:4096
    v_mfma_f32_16x16x32_bf16 v[0:3], v[80:83], v[56:59], v[0:3]
    v_mfma_f32_16x16x32_bf16 v[4:7], v[84:87], v[56:59], v[4:7]
    v_mfma_f32_16x16x32_bf16 v[20:23], v[84:87], v[60:63], v[20:23]
    v_mfma_f32_16x16x32_bf16 v[16:19], v[80:83], v[60:63], v[16:19]
    ds_read_b128 v[136:139], v251 offset:2048
    ds_read_b128 v[140:143], v251 offset:3072
    ds_read_b128 v[152:155], v252 offset:1024
    ds_read_b128 v[156:159], v252 offset:5120
    s_nop 1
    s_waitcnt lgkmcnt(6)
    v_pk_add_f32 v[0:1], v[0:1], v[128:129]
    v_pk_add_f32 v[2:3], v[2:3], v[130:131]
    v_pk_add_f32 v[4:5], v[4:5], v[132:133]
    v_pk_add_f32 v[6:7], v[6:7], v[134:135]
    v_pk_mul_f32 v[160:161], v[0:1], s[64:65]
    v_pk_mul_f32 v[162:163], v[2:3], s[64:65]
    v_pk_mul_f32 v[164:165], v[4:5], s[64:65]
    v_pk_mul_f32 v[166:167], v[6:7], s[64:65]
    v_exp_f32 v160, v160
    v_exp_f32 v161, v161
    v_exp_f32 v162, v162
    v_exp_f32 v163, v163
    v_exp_f32 v164, v164
    v_exp_f32 v165, v165
    v_exp_f32 v166, v166
    v_exp_f32 v167, v167
    s_waitcnt lgkmcnt(4)
    v_pk_mul_f32 v[0:1], v[0:1], v[144:145]
    v_pk_mul_f32 v[2:3], v[2:3], v[146:147]
    v_pk_mul_f32 v[4:5], v[4:5], v[148:149]
    v_pk_mul_f32 v[6:7], v[6:7], v[150:151]
    v_pk_add_f32 v[160:161], v[160:161], 1.0 op_sel_hi:[1,0]
    v_pk_add_f32 v[162:163], v[162:163], 1.0 op_sel_hi:[1,0]
    v_pk_add_f32 v[164:165], v[164:165], 1.0 op_sel_hi:[1,0]
    v_pk_add_f32 v[166:167], v[166:167], 1.0 op_sel_hi:[1,0]
    v_rcp_f32 v160, v160
    v_rcp_f32 v161, v161
    v_rcp_f32 v162, v162
    v_rcp_f32 v163, v163
    v_rcp_f32 v164, v164
    v_rcp_f32 v165, v165
    v_rcp_f32 v166, v166
    v_rcp_f32 v167, v167
    v_pk_fma_f32 v[0:1], v[0:1], v[160:161], v[112:113]
    v_pk_fma_f32 v[2:3], v[2:3], v[162:163], v[114:115]
    v_pk_fma_f32 v[4:5], v[4:5], v[164:165], v[116:117]
    v_pk_fma_f32 v[6:7], v[6:7], v[166:167], v[118:119]
    v_cvt_pk_bf16_f32 v168, v0, v1
    v_cvt_pk_bf16_f32 v169, v2, v3
    v_cvt_pk_bf16_f32 v170, v4, v5
    v_cvt_pk_bf16_f32 v171, v6, v7
    s_nop 1
    v_permlane16_swap_b32 v168, v170
    v_permlane16_swap_b32 v169, v171
    buffer_store_dwordx4 v[168:171], v246, s[28:31], s77 offen sc1
    s_waitcnt lgkmcnt(2)
    v_pk_add_f32 v[16:17], v[16:17], v[136:137]
    v_pk_add_f32 v[18:19], v[18:19], v[138:139]
    v_pk_add_f32 v[20:21], v[20:21], v[140:141]
    v_pk_add_f32 v[22:23], v[22:23], v[142:143]
    v_pk_mul_f32 v[160:161], v[16:17], s[64:65]
    v_pk_mul_f32 v[162:163], v[18:19], s[64:65]
    v_pk_mul_f32 v[164:165], v[20:21], s[64:65]
    v_pk_mul_f32 v[166:167], v[22:23], s[64:65]
    v_exp_f32 v160, v160
    v_exp_f32 v161, v161
    v_exp_f32 v162, v162
    v_exp_f32 v163, v163
    v_exp_f32 v164, v164
    v_exp_f32 v165, v165
    v_exp_f32 v166, v166
    v_exp_f32 v167, v167
    s_waitcnt lgkmcnt(0)
    v_pk_mul_f32 v[16:17], v[16:17], v[152:153]
    v_pk_mul_f32 v[18:19], v[18:19], v[154:155]
    v_pk_mul_f32 v[20:21], v[20:21], v[156:157]
    v_pk_mul_f32 v[22:23], v[22:23], v[158:159]
    v_pk_add_f32 v[160:161], v[160:161], 1.0 op_sel_hi:[1,0]
    v_pk_add_f32 v[162:163], v[162:163], 1.0 op_sel_hi:[1,0]
    v_pk_add_f32 v[164:165], v[164:165], 1.0 op_sel_hi:[1,0]
    v_pk_add_f32 v[166:167], v[166:167], 1.0 op_sel_hi:[1,0]
    v_rcp_f32 v160, v160
    v_rcp_f32 v161, v161
    v_rcp_f32 v162, v162
    v_rcp_f32 v163, v163
    v_rcp_f32 v164, v164
    v_rcp_f32 v165, v165
    v_rcp_f32 v166, v166
    v_rcp_f32 v167, v167
    v_pk_fma_f32 v[16:17], v[16:17], v[160:161], v[120:121]
    v_pk_fma_f32 v[18:19], v[18:19], v[162:163], v[122:123]
    v_pk_fma_f32 v[20:21], v[20:21], v[164:165], v[124:125]
    v_pk_fma_f32 v[22:23], v[22:23], v[166:167], v[126:127]
    v_cvt_pk_bf16_f32 v172, v16, v17
    v_cvt_pk_bf16_f32 v173, v18, v19
    v_cvt_pk_bf16_f32 v174, v20, v21
    v_cvt_pk_bf16_f32 v175, v22, v23
    s_nop 1
    v_permlane16_swap_b32 v172, v174
    v_permlane16_swap_b32 v173, v175
    buffer_store_dwordx4 v[172:175], v246, s[28:31], s78 offen sc1
    s_endpgm
L_part_b:
L_sp_3:
    s_barrier
    ds_read_b64_tr_b16 v[128:129], v224 offset:0
    ds_read_b64_tr_b16 v[130:131], v225 offset:0
    ds_read_b64_tr_b16 v[132:133], v224 offset:256
    ds_read_b64_tr_b16 v[134:135], v225 offset:256
    ds_read_b64_tr_b16 v[136:137], v224 offset:512
    ds_read_b64_tr_b16 v[138:139], v225 offset:512
    ds_read_b64_tr_b16 v[140:141], v224 offset:768
    ds_read_b64_tr_b16 v[142:143], v225 offset:768
    ds_read_b64_tr_b16 v[144:145], v224 offset:4096
    ds_read_b64_tr_b16 v[146:147], v225 offset:4096
    v_lshrrev_b32 v252, 4, v255
    v_and_b32 v253, 15, v255
    v_lshlrev_b32 v253, 3, v253
    v_mul_u32_u24 v252, 278528, v252
    v_add_u32 v253, v253, v252
    s_waitcnt lgkmcnt(8)
    v_mfma_f32_16x16x32_bf16 v[0:3], v[128:131], v[192:195], 0
    ds_read_b64_tr_b16 v[148:149], v224 offset:4352
    v_mfma_f32_16x16x32_bf16 v[4:7], v[128:131], v[208:211], 0
    ds_read_b64_tr_b16 v[150:151], v225 offset:4352
    s_waitcnt lgkmcnt(8)
    v_mfma_f32_16x16x32_bf16 v[0:3], v[132:135], v[196:199], v[0:3]
    ds_read_b64_tr_b16 v[128:129], v224 offset:4608
    v_mfma_f32_16x16x32_bf16 v[4:7], v[132:135], v[212:215], v[4:7]
    ds_read_b64_tr_b16 v[130:131], v225 offset:4608
    s_waitcnt lgkmcnt(8)
    v_mfma_f32_16x16x32_bf16 v[0:3], v[136:139], v[200:203], v[0:3]
    ds_read_b64_tr_b16 v[132:133], v224 offset:4864
    v_mfma_f32_16x16x32_bf16 v[4:7], v[136:139], v[216:219], v[4:7]
    ds_read_b64_tr_b16 v[134:135], v225 offset:4864
    s_waitcnt lgkmcnt(8)
    v_mfma_f32_16x16x32_bf16 v[0:3], v[140:143], v[204:207], v[0:3]
    ds_read_b64_tr_b16 v[136:137], v224 offset:8192
    v_mfma_f32_16x16x32_bf16 v[4:7], v[140:143], v[220:223], v[4:7]
    ds_read_b64_tr_b16 v[138:139], v225 offset:8192
    s_waitcnt lgkmcnt(8)
    v_mfma_f32_16x16x32_bf16 v[8:11], v[144:147], v[192:195], 0
    ds_read_b64_tr_b16 v[140:141], v224 offset:8448
    v_mfma_f32_16x16x32_bf16 v[12:15], v[144:147], v[208:211], 0
    ds_read_b64_tr_b16 v[142:143], v225 offset:8448
    s_waitcnt lgkmcnt(8)
    v_mfma_f32_16x16x32_bf16 v[8:11], v[148:151], v[196:199], v[8:11]
    ds_read_b64_tr_b16 v[144:145], v224 offset:8704
    v_mfma_f32_16x16x32_bf16 v[12:15], v[148:151], v[212:215], v[12:15]
    ds_read_b64_tr_b16 v[146:147], v225 offset:8704
    s_waitcnt lgkmcnt(8)
    v_mfma_f32_16x16x32_bf16 v[8:11], v[128:131], v[200:203], v[8:11]
    ds_read_b64_tr_b16 v[148:149], v224 offset:8960
    v_mfma_f32_16x16x32_bf16 v[12:15], v[128:131], v[216:219], v[12:15]
    ds_read_b64_tr_b16 v[150:151], v225 offset:8960
    s_waitcnt lgkmcnt(8)
    v_mfma_f32_16x16x32_bf16 v[8:11], v[132:135], v[204:207], v[8:11]
    ds_read_b64_tr_b16 v[128:129], v224 offset:12288
    v_mfma_f32_16x16x32_bf16 v[12:15], v[132:135], v[220:223], v[12:15]
    ds_read_b64_tr_b16 v[130:131], v225 offset:12288
    s_waitcnt lgkmcnt(8)
    v_mfma_f32_16x16x32_bf16 v[16:19], v[136:139], v[192:195], 0
    ds_read_b64_tr_b16 v[132:133], v224 offset:12544
    v_mfma_f32_16x16x32_bf16 v[20:23], v[136:139], v[208:211], 0
    ds_read_b64_tr_b16 v[134:135], v225 offset:12544
    s_waitcnt lgkmcnt(8)
    v_mfma_f32_16x16x32_bf16 v[16:19], v[140:143], v[196:199], v[16:19]
    ds_read_b64_tr_b16 v[136:137], v224 offset:12800
    v_mfma_f32_16x16x32_bf16 v[20:23], v[140:143], v[212:215], v[20:23]
    ds_read_b64_tr_b16 v[138:139], v225 offset:12800
    s_waitcnt lgkmcnt(8)
    v_mfma_f32_16x16x32_bf16 v[16:19], v[144:147], v[200:203], v[16:19]
    ds_read_b64_tr_b16 v[140:141], v224 offset:13056
    v_mfma_f32_16x16x32_bf16 v[20:23], v[144:147], v[216:219], v[20:23]
    ds_read_b64_tr_b16 v[142:143], v225 offset:13056
    s_waitcnt lgkmcnt(8)
    v_mfma_f32_16x16x32_bf16 v[16:19], v[148:151], v[204:207], v[16:19]
    ds_read_b64_tr_b16 v[144:145], v224 offset:16384
    v_mfma_f32_16x16x32_bf16 v[20:23], v[148:151], v[220:223], v[20:23]
    ds_read_b64_tr_b16 v[146:147], v225 offset:16384
    s_waitcnt lgkmcnt(8)
    v_mfma_f32_16x16x32_bf16 v[24:27], v[128:131], v[192:195], 0
    ds_read_b64_tr_b16 v[148:149], v224 offset:16640
    v_mfma_f32_16x16x32_bf16 v[28:31], v[128:131], v[208:211], 0
    ds_read_b64_tr_b16 v[150:151], v225 offset:16640
    s_waitcnt lgkmcnt(8)
    v_mfma_f32_16x16x32_bf16 v[24:27], v[132:135], v[196:199], v[24:27]
    ds_read_b64_tr_b16 v[128:129], v224 offset:16896
    v_mfma_f32_16x16x32_bf16 v[28:31], v[132:135], v[212:215], v[28:31]
    ds_read_b64_tr_b16 v[130:131], v225 offset:16896
    s_waitcnt lgkmcnt(8)
    v_mfma_f32_16x16x32_bf16 v[24:27], v[136:139], v[200:203], v[24:27]
    ds_read_b64_tr_b16 v[132:133], v224 offset:17152
    v_mfma_f32_16x16x32_bf16 v[28:31], v[136:139], v[216:219], v[28:31]
    ds_read_b64_tr_b16 v[134:135], v225 offset:17152
    s_waitcnt lgkmcnt(8)
    v_mfma_f32_16x16x32_bf16 v[24:27], v[140:143], v[204:207], v[24:27]
    ds_read_b64_tr_b16 v[136:137], v224 offset:20480
    v_mfma_f32_16x16x32_bf16 v[28:31], v[140:143], v[220:223], v[28:31]
    ds_read_b64_tr_b16 v[138:139], v225 offset:20480
    s_waitcnt lgkmcnt(8)
    v_mfma_f32_16x16x32_bf16 v[32:35], v[144:147], v[192:195], 0
    ds_read_b64_tr_b16 v[140:141], v224 offset:20736
    v_mfma_f32_16x16x32_bf16 v[36:39], v[144:147], v[208:211], 0
    ds_read_b64_tr_b16 v[142:143], v225 offset:20736
    s_waitcnt lgkmcnt(8)
    v_mfma_f32_16x16x32_bf16 v[32:35], v[148:151], v[196:199], v[32:35]
    ds_read_b64_tr_b16 v[144:145], v224 offset:20992
    v_mfma_f32_16x16x32_bf16 v[36:39], v[148:151], v[212:215], v[36:39]
    ds_read_b64_tr_b16 v[146:147], v225 offset:20992
    s_waitcnt lgkmcnt(8)
    v_mfma_f32_16x16x32_bf16 v[32:35], v[128:131], v[200:203], v[32:35]
    ds_read_b64_tr_b16 v[148:149], v224 offset:21248
    v_mfma_f32_16x16x32_bf16 v[36:39], v[128:131], v[216:219], v[36:39]
    ds_read_b64_tr_b16 v[150:151], v225 offset:21248
    s_waitcnt lgkmcnt(8)
    v_mfma_f32_16x16x32_bf16 v[32:35], v[132:135], v[204:207], v[32:35]
    ds_read_b64_tr_b16 v[128:129], v224 offset:24576
    v_mfma_f32_16x16x32_bf16 v[36:39], v[132:135], v[220:223], v[36:39]
    ds_read_b64_tr_b16 v[130:131], v225 offset:24576
    s_waitcnt lgkmcnt(8)
    v_mfma_f32_16x16x32_bf16 v[40:43], v[136:139], v[192:195], 0
    ds_read_b64_tr_b16 v[132:133], v224 offset:24832
    v_mfma_f32_16x16x32_bf16 v[44:47], v[136:139], v[208:211], 0
    ds_read_b64_tr_b16 v[134:135], v225 offset:24832
    s_waitcnt lgkmcnt(8)
    v_mfma_f32_16x16x32_bf16 v[40:43], v[140:143], v[196:199], v[40:43]
    ds_read_b64_tr_b16 v[136:137], v224 offset:25088
    v_mfma_f32_16x16x32_bf16 v[44:47], v[140:143], v[212:215], v[44:47]
    ds_read_b64_tr_b16 v[138:139], v225 offset:25088
    s_waitcnt lgkmcnt(8)
    v_mfma_f32_16x16x32_bf16 v[40:43], v[144:147], v[200:203], v[40:43]
    ds_read_b64_tr_b16 v[140:141], v224 offset:25344
    v_mfma_f32_16x16x32_bf16 v[44:47], v[144:147], v[216:219], v[44:47]
    ds_read_b64_tr_b16 v[142:143], v225 offset:25344
    s_waitcnt lgkmcnt(8)
    v_mfma_f32_16x16x32_bf16 v[40:43], v[148:151], v[204:207], v[40:43]
    ds_read_b64_tr_b16 v[144:145], v224 offset:28672
    v_mfma_f32_16x16x32_bf16 v[44:47], v[148:151], v[220:223], v[44:47]
    ds_read_b64_tr_b16 v[146:147], v225 offset:28672
    s_waitcnt lgkmcnt(8)
    v_mfma_f32_16x16x32_bf16 v[48:51], v[128:131], v[192:195], 0
    ds_read_b64_tr_b16 v[148:149], v224 offset:28928
    v_mfma_f32_16x16x32_bf16 v[52:55], v[128:131], v[208:211], 0
    ds_read_b64_tr_b16 v[150:151], v225 offset:28928
    s_waitcnt lgkmcnt(8)
    v_mfma_f32_16x16x32_bf16 v[48:51], v[132:135], v[196:199], v[48:51]
    ds_read_b64_tr_b16 v[128:129], v224 offset:29184
    v_mfma_f32_16x16x32_bf16 v[52:55], v[132:135], v[212:215], v[52:55]
    ds_read_b64_tr_b16 v[130:131], v225 offset:29184
    s_waitcnt lgkmcnt(8)
    v_mfma_f32_16x16x32_bf16 v[48:51], v[136:139], v[200:203], v[48:51]
    ds_read_b64_tr_b16 v[132:133], v224 offset:29440
    v_mfma_f32_16x16x32_bf16 v[52:55], v[136:139], v[216:219], v[52:55]
    ds_read_b64_tr_b16 v[134:135], v225 offset:29440
    s_waitcnt lgkmcnt(8)
    s_barrier
    v_mfma_f32_16x16x32_bf16 v[48:51], v[140:143], v[204:207], v[48:51]
    ds_read_b64_tr_b16 v[136:137], v224 offset:32768
    v_mfma_f32_16x16x32_bf16 v[52:55], v[140:143], v[220:223], v[52:55]
    ds_read_b64_tr_b16 v[138:139], v225 offset:32768
    s_waitcnt lgkmcnt(8)
    v_mfma_f32_16x16x32_bf16 v[56:59], v[144:147], v[192:195], 0
    ds_read_b64_tr_b16 v[140:141], v224 offset:33024
    v_mfma_f32_16x16x32_bf16 v[60:63], v[144:147], v[208:211], 0
    ds_read_b64_tr_b16 v[142:143], v225 offset:33024
    s_waitcnt lgkmcnt(8)
    v_mfma_f32_16x16x32_bf16 v[56:59], v[148:151], v[196:199], v[56:59]
    ds_read_b64_tr_b16 v[144:145], v224 offset:33280
    v_mfma_f32_16x16x32_bf16 v[60:63], v[148:151], v[212:215], v[60:63]
    ds_read_b64_tr_b16 v[146:147], v225 offset:33280
    s_waitcnt lgkmcnt(8)
    v_mfma_f32_16x16x32_bf16 v[56:59], v[128:131], v[200:203], v[56:59]
    ds_read_b64_tr_b16 v[148:149], v224 offset:33536
    v_mfma_f32_16x16x32_bf16 v[60:63], v[128:131], v[216:219], v[60:63]
    ds_read_b64_tr_b16 v[150:151], v225 offset:33536
    s_waitcnt lgkmcnt(8)
    v_mfma_f32_16x16x32_bf16 v[56:59], v[132:135], v[204:207], v[56:59]
    ds_read_b64_tr_b16 v[128:129], v224 offset:36864
    v_mfma_f32_16x16x32_bf16 v[60:63], v[132:135], v[220:223], v[60:63]
    ds_read_b64_tr_b16 v[130:131], v225 offset:36864
    s_waitcnt lgkmcnt(8)
    v_mfma_f32_16x16x32_bf16 v[64:67], v[136:139], v[192:195], 0
    ds_read_b64_tr_b16 v[132:133], v224 offset:37120
    v_mfma_f32_16x16x32_bf16 v[68:71], v[136:139], v[208:211], 0
    ds_read_b64_tr_b16 v[134:135], v225 offset:37120
    s_waitcnt lgkmcnt(8)
    v_mfma_f32_16x16x32_bf16 v[64:67], v[140:143], v[196:199], v[64:67]
    ds_read_b64_tr_b16 v[136:137], v224 offset:37376
    v_mfma_f32_16x16x32_bf16 v[68:71], v[140:143], v[212:215], v[68:71]
    ds_read_b64_tr_b16 v[138:139], v225 offset:37376
    s_waitcnt lgkmcnt(8)
    v_mfma_f32_16x16x32_bf16 v[64:67], v[144:147], v[200:203], v[64:67]
    ds_read_b64_tr_b16 v[140:141], v224 offset:37632
    v_mfma_f32_16x16x32_bf16 v[68:71], v[144:147], v[216:219], v[68:71]
    ds_read_b64_tr_b16 v[142:143], v225 offset:37632
    s_waitcnt lgkmcnt(8)
    v_mfma_f32_16x16x32_bf16 v[64:67], v[148:151], v[204:207], v[64:67]
    ds_read_b64_tr_b16 v[144:145], v224 offset:40960
    v_mfma_f32_16x16x32_bf16 v[68:71], v[148:151], v[220:223], v[68:71]
    ds_read_b64_tr_b16 v[146:147], v225 offset:40960
    s_waitcnt lgkmcnt(8)
    v_mfma_f32_16x16x32_bf16 v[72:75], v[128:131], v[192:195], 0
    ds_read_b64_tr_b16 v[148:149], v224 offset:41216
    v_mfma_f32_16x16x32_bf16 v[76:79], v[128:131], v[208:211], 0
    ds_read_b64_tr_b16 v[150:151], v225 offset:41216
    s_waitcnt lgkmcnt(8)
    v_mfma_f32_16x16x32_bf16 v[72:75], v[132:135], v[196:199], v[72:75]
    ds_read_b64_tr_b16 v[128:129], v224 offset:41472
    v_mfma_f32_16x16x32_bf16 v[76:79], v[132:135], v[212:215], v[76:79]
    ds_read_b64_tr_b16 v[130:131], v225 offset:41472
    s_waitcnt lgkmcnt(8)
    v_mfma_f32_16x16x32_bf16 v[72:75], v[136:139], v[200:203], v[72:75]
    ds_read_b64_tr_b16 v[132:133], v224 offset:41728
    v_mfma_f32_16x16x32_bf16 v[76:79], v[136:139], v[216:219], v[76:79]
    ds_read_b64_tr_b16 v[134:135], v225 offset:41728
    s_waitcnt lgkmcnt(8)
    v_mfma_f32_16x16x32_bf16 v[72:75], v[140:143], v[204:207], v[72:75]
    ds_read_b64_tr_b16 v[136:137], v224 offset:45056
    v_mfma_f32_16x16x32_bf16 v[76:79], v[140:143], v[220:223], v[76:79]
    ds_read_b64_tr_b16 v[138:139], v225 offset:45056
    s_waitcnt lgkmcnt(8)
    v_mfma_f32_16x16x32_bf16 v[80:83], v[144:147], v[192:195], 0
    ds_read_b64_tr_b16 v[140:141], v224 offset:45312
    v_mfma_f32_16x16x32_bf16 v[84:87], v[144:147], v[208:211], 0
    ds_read_b64_tr_b16 v[142:143], v225 offset:45312
    s_waitcnt lgkmcnt(8)
    v_mfma_f32_16x16x32_bf16 v[80:83], v[148:151], v[196:199], v[80:83]
    ds_read_b64_tr_b16 v[144:145], v224 offset:45568
    v_mfma_f32_16x16x32_bf16 v[84:87], v[148:151], v[212:215], v[84:87]
    ds_read_b64_tr_b16 v[146:147], v225 offset:45568
    s_waitcnt lgkmcnt(8)
    v_mfma_f32_16x16x32_bf16 v[80:83], v[128:131], v[200:203], v[80:83]
    ds_read_b64_tr_b16 v[148:149], v224 offset:45824
    v_mfma_f32_16x16x32_bf16 v[84:87], v[128:131], v[216:219], v[84:87]
    ds_read_b64_tr_b16 v[150:151], v225 offset:45824
    s_waitcnt lgkmcnt(8)
    v_mfma_f32_16x16x32_bf16 v[80:83], v[132:135], v[204:207], v[80:83]
    ds_read_b64_tr_b16 v[128:129], v224 offset:49152
    v_mfma_f32_16x16x32_bf16 v[84:87], v[132:135], v[220:223], v[84:87]
    ds_read_b64_tr_b16 v[130:131], v225 offset:49152
    s_waitcnt lgkmcnt(8)
    v_mfma_f32_16x16x32_bf16 v[88:91], v[136:139], v[192:195], 0
    ds_read_b64_tr_b16 v[132:133], v224 offset:49408
    v_mfma_f32_16x16x32_bf16 v[92:95], v[136:139], v[208:211], 0
    ds_read_b64_tr_b16 v[134:135], v225 offset:49408
    s_waitcnt lgkmcnt(8)
    v_mfma_f32_16x16x32_bf16 v[88:91], v[140:143], v[196:199], v[88:91]
    ds_read_b64_tr_b16 v[136:137], v224 offset:49664
    v_mfma_f32_16x16x32_bf16 v[92:95], v[140:143], v[212:215], v[92:95]
    ds_read_b64_tr_b16 v[138:139], v225 offset:49664
    s_waitcnt lgkmcnt(8)
    v_mfma_f32_16x16x32_bf16 v[88:91], v[144:147], v[200:203], v[88:91]
    ds_read_b64_tr_b16 v[140:141], v224 offset:49920
    v_mfma_f32_16x16x32_bf16 v[92:95], v[144:147], v[216:219], v[92:95]
    ds_read_b64_tr_b16 v[142:143], v225 offset:49920
    s_waitcnt lgkmcnt(8)
    v_mfma_f32_16x16x32_bf16 v[88:91], v[148:151], v[204:207], v[88:91]
    ds_read_b64_tr_b16 v[144:145], v224 offset:53248
    v_mfma_f32_16x16x32_bf16 v[92:95], v[148:151], v[220:223], v[92:95]
    ds_read_b64_tr_b16 v[146:147], v225 offset:53248
    s_waitcnt lgkmcnt(8)
    v_mfma_f32_16x16x32_bf16 v[96:99], v[128:131], v[192:195], 0
    ds_read_b64_tr_b16 v[148:149], v224 offset:53504
    v_mfma_f32_16x16x32_bf16 v[100:103], v[128:131], v[208:211], 0
    ds_read_b64_tr_b16 v[150:151], v225 offset:53504
    s_waitcnt lgkmcnt(8)
    v_mfma_f32_16x16x32_bf16 v[96:99], v[132:135], v[196:199], v[96:99]
    ds_read_b64_tr_b16 v[128:129], v224 offset:53760
    v_mfma_f32_16x16x32_bf16 v[100:103], v[132:135], v[212:215], v[100:103]
    ds_read_b64_tr_b16 v[130:131], v225 offset:53760
    s_waitcnt lgkmcnt(8)
    v_mfma_f32_16x16x32_bf16 v[96:99], v[136:139], v[200:203], v[96:99]
    ds_read_b64_tr_b16 v[132:133], v224 offset:54016
    v_mfma_f32_16x16x32_bf16 v[100:103], v[136:139], v[216:219], v[100:103]
    ds_read_b64_tr_b16 v[134:135], v225 offset:54016
    s_waitcnt lgkmcnt(8)
    v_mfma_f32_16x16x32_bf16 v[96:99], v[140:143], v[204:207], v[96:99]
    ds_read_b64_tr_b16 v[136:137], v224 offset:57344
    v_mfma_f32_16x16x32_bf16 v[100:103], v[140:143], v[220:223], v[100:103]
    ds_read_b64_tr_b16 v[138:139], v225 offset:57344
    s_waitcnt lgkmcnt(8)
    v_mfma_f32_16x16x32_bf16 v[104:107], v[144:147], v[192:195], 0
    ds_read_b64_tr_b16 v[140:141], v224 offset:57600
    v_mfma_f32_16x16x32_bf16 v[108:111], v[144:147], v[208:211], 0
    ds_read_b64_tr_b16 v[142:143], v225 offset:57600
    s_waitcnt lgkmcnt(8)
    v_mfma_f32_16x16x32_bf16 v[104:107], v[148:151], v[196:199], v[104:107]
    ds_read_b64_tr_b16 v[144:145], v224 offset:57856
    v_mfma_f32_16x16x32_bf16 v[108:111], v[148:151], v[212:215], v[108:111]
    ds_read_b64_tr_b16 v[146:147], v225 offset:57856
    s_waitcnt lgkmcnt(8)
    v_mfma_f32_16x16x32_bf16 v[104:107], v[128:131], v[200:203], v[104:107]
    ds_read_b64_tr_b16 v[148:149], v224 offset:58112
    v_mfma_f32_16x16x32_bf16 v[108:111], v[128:131], v[216:219], v[108:111]
    ds_read_b64_tr_b16 v[150:151], v225 offset:58112
    s_waitcnt lgkmcnt(8)
    v_mfma_f32_16x16x32_bf16 v[104:107], v[132:135], v[204:207], v[104:107]
    ds_read_b64_tr_b16 v[128:129], v224 offset:61440
    v_mfma_f32_16x16x32_bf16 v[108:111], v[132:135], v[220:223], v[108:111]
    ds_read_b64_tr_b16 v[130:131], v225 offset:61440
    s_waitcnt lgkmcnt(8)
    v_mfma_f32_16x16x32_bf16 v[112:115], v[136:139], v[192:195], 0
    ds_read_b64_tr_b16 v[132:133], v224 offset:61696
    v_mfma_f32_16x16x32_bf16 v[116:119], v[136:139], v[208:211], 0
    ds_read_b64_tr_b16 v[134:135], v225 offset:61696
    s_waitcnt lgkmcnt(8)
    v_mfma_f32_16x16x32_bf16 v[112:115], v[140:143], v[196:199], v[112:115]
    ds_read_b64_tr_b16 v[136:137], v224 offset:61952
    v_mfma_f32_16x16x32_bf16 v[116:119], v[140:143], v[212:215], v[116:119]
    ds_read_b64_tr_b16 v[138:139], v225 offset:61952
    s_waitcnt lgkmcnt(8)
    v_mfma_f32_16x16x32_bf16 v[112:115], v[144:147], v[200:203], v[112:115]
    ds_read_b64_tr_b16 v[140:141], v224 offset:62208
    v_mfma_f32_16x16x32_bf16 v[116:119], v[144:147], v[216:219], v[116:119]
    ds_read_b64_tr_b16 v[142:143], v225 offset:62208
    s_waitcnt lgkmcnt(8)
    v_mfma_f32_16x16x32_bf16 v[112:115], v[148:151], v[204:207], v[112:115]
    v_mfma_f32_16x16x32_bf16 v[116:119], v[148:151], v[220:223], v[116:119]
    s_waitcnt lgkmcnt(6)
    v_mfma_f32_16x16x32_bf16 v[120:123], v[128:131], v[192:195], 0
    v_mfma_f32_16x16x32_bf16 v[124:127], v[128:131], v[208:211], 0
    s_waitcnt lgkmcnt(4)
    v_mfma_f32_16x16x32_bf16 v[120:123], v[132:135], v[196:199], v[120:123]
    v_mfma_f32_16x16x32_bf16 v[124:127], v[132:135], v[212:215], v[124:127]
    s_waitcnt lgkmcnt(2)
    v_mfma_f32_16x16x32_bf16 v[120:123], v[136:139], v[200:203], v[120:123]
    v_mfma_f32_16x16x32_bf16 v[124:127], v[136:139], v[216:219], v[124:127]
    s_waitcnt lgkmcnt(0)
    v_mfma_f32_16x16x32_bf16 v[120:123], v[140:143], v[204:207], v[120:123]
    v_mfma_f32_16x16x32_bf16 v[124:127], v[140:143], v[220:223], v[124:127]
    s_barrier
    ds_read_b128 v[128:131], v227 offset:0
    ds_read_b128 v[132:135], v227 offset:16
    ds_read_b128 v[136:139], v227 offset:32
    ds_read_b128 v[140:143], v227 offset:48
    s_cmp_lg_u32 s56, 3
    s_cbranch_scc1 L_n0_43
    ds_read_b128 v[160:163], v227 offset:256
    ds_read_b128 v[164:167], v227 offset:272
    ds_read_b128 v[168:171], v227 offset:288
    ds_read_b128 v[172:175], v227 offset:304
    s_waitcnt lgkmcnt(0)
    v_cvt_pk_bf16_f32 v144, v160, v161
    v_cvt_pk_bf16_f32 v145, v162, v163
    v_cvt_pk_bf16_f32 v146, v164, v165
    v_cvt_pk_bf16_f32 v147, v166, v167
    v_cvt_pk_bf16_f32 v148, v168, v169
    v_cvt_pk_bf16_f32 v149, v170, v171
    v_cvt_pk_bf16_f32 v150, v172, v173
    v_cvt_pk_bf16_f32 v151, v174, v175
    s_nop 1
    v_mfma_f32_16x16x32_bf16 v[192:195], v[228:231], v[144:147], 0
    v_mfma_f32_16x16x32_bf16 v[196:199], v[244:247], v[144:147], 0
    v_mfma_f32_16x16x32_bf16 v[200:203], v[228:231], v[148:151], 0
    v_mfma_f32_16x16x32_bf16 v[204:207], v[244:247], v[148:151], 0
    v_mfma_f32_16x16x32_bf16 v[208:211], v[232:235], v[144:147], 0
    v_mfma_f32_16x16x32_bf16 v[212:215], v[248:251], v[144:147], 0
    v_mfma_f32_16x16x32_bf16 v[216:219], v[232:235], v[148:151], 0
    v_mfma_f32_16x16x32_bf16 v[220:223], v[248:251], v[148:151], 0
    s_nop 3
    v_cvt_pk_bf16_f32 v160, v192, v196
    v_cvt_pk_bf16_f32 v161, v200, v204
    s_add_u32 s63, s90, 53248
    buffer_store_dwordx2 v[160:161], v253, s[20:23], s63 offen sc1
    v_cvt_pk_bf16_f32 v162, v193, v197
    v_cvt_pk_bf16_f32 v163, v201, v205
    s_add_u32 s63, s90, 122880
    buffer_store_dwordx2 v[162:163], v253, s[20:23], s63 offen sc1
    v_cvt_pk_bf16_f32 v164, v194, v198
    v_cvt_pk_bf16_f32 v165, v202, v206
    s_add_u32 s63, s90, 192512
    buffer_store_dwordx2 v[164:165], v253, s[20:23], s63 offen sc1
    v_cvt_pk_bf16_f32 v166, v195, v199
    v_cvt_pk_bf16_f32 v167, v203, v207
    s_add_u32 s63, s90, 262144
    buffer_store_dwordx2 v[166:167], v253, s[20:23], s63 offen sc1
    v_cvt_pk_bf16_f32 v168, v208, v212
    v_cvt_pk_bf16_f32 v169, v216, v220
    s_add_u32 s63, s90, 1167360
    buffer_store_dwordx2 v[168:169], v253, s[20:23], s63 offen sc1
    v_cvt_pk_bf16_f32 v170, v209, v213
    v_cvt_pk_bf16_f32 v171, v217, v221
    s_add_u32 s63, s90, 1236992
    buffer_store_dwordx2 v[170:171], v253, s[20:23], s63 offen sc1
    v_cvt_pk_bf16_f32 v172, v210, v214
    v_cvt_pk_bf16_f32 v173, v218, v222
    s_add_u32 s63, s90, 1306624
    buffer_store_dwordx2 v[172:173], v253, s[20:23], s63 offen sc1
    v_cvt_pk_bf16_f32 v174, v211, v215
    v_cvt_pk_bf16_f32 v175, v219, v223
    s_add_u32 s63, s90, 1376256
    buffer_store_dwordx2 v[174:175], v253, s[20:23], s63 offen sc1
L_n0_43:
    s_mov_b32 s64, 0x3f3504f3
    s_cmp_lg_u32 s56, 0
    s_waitcnt lgkmcnt(0)
    v_pk_mul_f32 v[0:1], v[0:1], v[128:129] op_sel_hi:[1,0]
    v_pk_mul_f32 v[2:3], v[2:3], v[128:129] op_sel_hi:[1,0]
    v_pk_mul_f32 v[4:5], v[4:5], v[128:129] op_sel_hi:[1,0]
    v_pk_mul_f32 v[6:7], v[6:7], v[128:129] op_sel_hi:[1,0]
    v_pk_mul_f32 v[144:145], v[0:1], v[152:153]
    v_pk_mul_f32 v[148:149], v[4:5], v[152:153]
    v_pk_mul_f32 v[146:147], v[2:3], v[154:155]
    v_pk_mul_f32 v[150:151], v[6:7], v[154:155]
    v_pk_fma_f32 v[144:145], v[4:5], v[156:157], v[144:145] neg_lo:[1,0,0] neg_hi:[1,0,0]
    v_pk_fma_f32 v[148:149], v[0:1], v[156:157], v[148:149]
    v_pk_fma_f32 v[146:147], v[6:7], v[158:159], v[146:147] neg_lo:[1,0,0] neg_hi:[1,0,0]
    v_pk_fma_f32 v[150:151], v[2:3], v[158:159], v[150:151]
    v_pk_add_f32 v[176:177], v[144:145], v[146:147]
    v_pk_add_f32 v[178:179], v[148:149], v[150:151]
    v_pk_add_f32 v[180:181], v[144:145], v[146:147] neg_lo:[0,1] neg_hi:[0,1]
    v_pk_add_f32 v[182:183], v[148:149], v[150:151] neg_lo:[0,1] neg_hi:[0,1]
    v_pk_add_f32 v[160:161], v[176:177], v[176:177] op_sel:[0,1] op_sel_hi:[0,1] neg_hi:[0,1]
    v_pk_add_f32 v[162:163], v[178:179], v[178:179] op_sel:[0,1] op_sel_hi:[0,1] neg_hi:[1,0]
    v_pk_add_f32 v[164:165], v[180:181], v[182:183] op_sel:[0,1] op_sel_hi:[0,1] neg_hi:[0,1]
    v_pk_add_f32 v[166:167], v[182:183], v[180:181] op_sel:[0,1] op_sel_hi:[0,1] neg_lo:[0,1] neg_hi:[1,1]
    s_cbranch_scc1 L_nsp_44
    s_mov_b64 exec, s[40:41]
    v_mov_b32 v160, v161
    v_mov_b32 v162, 0
    v_mov_b32 v164, v180
    v_sub_f32 v166, 0, v181
    v_fma_f32 v165, s64, v183, v4
    v_fma_f32 v161, -s64, v183, v4
    v_fma_f32 v167, -s64, v179, -v6
    v_fma_f32 v163, -s64, v179, v6
    s_mov_b64 exec, -1
L_nsp_44:
    v_pk_mul_f32 v[8:9], v[8:9], v[128:129] op_sel:[0,1] op_sel_hi:[1,1]
    v_pk_mul_f32 v[10:11], v[10:11], v[128:129] op_sel:[0,1] op_sel_hi:[1,1]
    v_pk_mul_f32 v[12:13], v[12:13], v[128:129] op_sel:[0,1] op_sel_hi:[1,1]
    v_pk_mul_f32 v[14:15], v[14:15], v[128:129] op_sel:[0,1] op_sel_hi:[1,1]
    v_pk_mul_f32 v[144:145], v[8:9], v[152:153]
    v_pk_mul_f32 v[148:149], v[12:13], v[152:153]
    v_pk_mul_f32 v[146:147], v[10:11], v[154:155]
    v_pk_mul_f32 v[150:151], v[14:15], v[154:155]
    v_pk_fma_f32 v[144:145], v[12:13], v[156:157], v[144:145] neg_lo:[1,0,0] neg_hi:[1,0,0]
    v_pk_fma_f32 v[148:149], v[8:9], v[156:157], v[148:149]
    v_pk_fma_f32 v[146:147], v[14:15], v[158:159], v[146:147] neg_lo:[1,0,0] neg_hi:[1,0,0]
    v_pk_fma_f32 v[150:151], v[10:11], v[158:159], v[150:151]
    v_pk_add_f32 v[176:177], v[144:145], v[146:147]
    v_pk_add_f32 v[178:179], v[148:149], v[150:151]
    v_pk_add_f32 v[180:181], v[144:145], v[146:147] neg_lo:[0,1] neg_hi:[0,1]
    v_pk_add_f32 v[182:183], v[148:149], v[150:151] neg_lo:[0,1] neg_hi:[0,1]
    v_pk_add_f32 v[168:169], v[176:177], v[176:177] op_sel:[0,1] op_sel_hi:[0,1] neg_hi:[0,1]
    v_pk_add_f32 v[170:171], v[178:179], v[178:179] op_sel:[0,1] op_sel_hi:[0,1] neg_hi:[1,0]
    v_pk_add_f32 v[172:173], v[180:181], v[182:183] op_sel:[0,1] op_sel_hi:[0,1] neg_hi:[0,1]
    v_pk_add_f32 v[174:175], v[182:183], v[180:181] op_sel:[0,1] op_sel_hi:[0,1] neg_lo:[0,1] neg_hi:[1,1]
    s_cbranch_scc1 L_nsp_45
    s_mov_b64 exec, s[40:41]
    v_mov_b32 v168, v169
    v_mov_b32 v170, 0
    v_mov_b32 v172, v180
    v_sub_f32 v174, 0, v181
    v_fma_f32 v173, s64, v183, v12
    v_fma_f32 v169, -s64, v183, v12
    v_fma_f32 v175, -s64, v179, -v14
    v_fma_f32 v171, -s64, v179, v14
    s_mov_b64 exec, -1
L_nsp_45:
    v_cvt_pk_bf16_f32 v192, v160, v168
    v_cvt_pk_bf16_f32 v196, v162, v170
    v_cvt_pk_bf16_f32 v200, v165, v173
    v_cvt_pk_bf16_f32 v204, v167, v175
    v_cvt_pk_bf16_f32 v208, v164, v172
    v_cvt_pk_bf16_f32 v212, v166, v174
    v_cvt_pk_bf16_f32 v216, v161, v169
    v_cvt_pk_bf16_f32 v220, v163, v171
    v_pk_mul_f32 v[16:17], v[16:17], v[130:131] op_sel_hi:[1,0]
    v_pk_mul_f32 v[18:19], v[18:19], v[130:131] op_sel_hi:[1,0]
    v_pk_mul_f32 v[20:21], v[20:21], v[130:131] op_sel_hi:[1,0]
    v_pk_mul_f32 v[22:23], v[22:23], v[130:131] op_sel_hi:[1,0]
    v_pk_mul_f32 v[144:145], v[16:17], v[152:153]
    v_pk_mul_f32 v[148:149], v[20:21], v[152:153]
    v_pk_mul_f32 v[146:147], v[18:19], v[154:155]
    v_pk_mul_f32 v[150:151], v[22:23], v[154:155]
    v_pk_fma_f32 v[144:145], v[20:21], v[156:157], v[144:145] neg_lo:[1,0,0] neg_hi:[1,0,0]
    v_pk_fma_f32 v[148:149], v[16:17], v[156:157], v[148:149]
    v_pk_fma_f32 v[146:147], v[22:23], v[158:159], v[146:147] neg_lo:[1,0,0] neg_hi:[1,0,0]
    v_pk_fma_f32 v[150:151], v[18:19], v[158:159], v[150:151]
    v_pk_add_f32 v[176:177], v[144:145], v[146:147]
    v_pk_add_f32 v[178:179], v[148:149], v[150:151]
    v_pk_add_f32 v[180:181], v[144:145], v[146:147] neg_lo:[0,1] neg_hi:[0,1]
    v_pk_add_f32 v[182:183], v[148:149], v[150:151] neg_lo:[0,1] neg_hi:[0,1]
    v_pk_add_f32 v[160:161], v[176:177], v[176:177] op_sel:[0,1] op_sel_hi:[0,1] neg_hi:[0,1]
    v_pk_add_f32 v[162:163], v[178:179], v[178:179] op_sel:[0,1] op_sel_hi:[0,1] neg_hi:[1,0]
    v_pk_add_f32 v[164:165], v[180:181], v[182:183] op_sel:[0,1] op_sel_hi:[0,1] neg_hi:[0,1]
    v_pk_add_f32 v[166:167], v[182:183], v[180:181] op_sel:[0,1] op_sel_hi:[0,1] neg_lo:[0,1] neg_hi:[1,1]
    s_cbranch_scc1 L_nsp_46
    s_mov_b64 exec, s[40:41]
    v_mov_b32 v160, v161
    v_mov_b32 v162, 0
    v_mov_b32 v164, v180
    v_sub_f32 v166, 0, v181
    v_fma_f32 v165, s64, v183, v20
    v_fma_f32 v161, -s64, v183, v20
    v_fma_f32 v167, -s64, v179, -v22
    v_fma_f32 v163, -s64, v179, v22
    s_mov_b64 exec, -1
L_nsp_46:
    v_pk_mul_f32 v[24:25], v[24:25], v[130:131] op_sel:[0,1] op_sel_hi:[1,1]
    v_pk_mul_f32 v[26:27], v[26:27], v[130:131] op_sel:[0,1] op_sel_hi:[1,1]
    v_pk_mul_f32 v[28:29], v[28:29], v[130:131] op_sel:[0,1] op_sel_hi:[1,1]
    v_pk_mul_f32 v[30:31], v[30:31], v[130:131] op_sel:[0,1] op_sel_hi:[1,1]
    v_pk_mul_f32 v[144:145], v[24:25], v[152:153]
    v_pk_mul_f32 v[148:149], v[28:29], v[152:153]
    v_pk_mul_f32 v[146:147], v[26:27], v[154:155]
    v_pk_mul_f32 v[150:151], v[30:31], v[154:155]
    v_pk_fma_f32 v[144:145], v[28:29], v[156:157], v[144:145] neg_lo:[1,0,0] neg_hi:[1,0,0]
    v_pk_fma_f32 v[148:149], v[24:25], v[156:157], v[148:149]
    v_pk_fma_f32 v[146:147], v[30:31], v[158:159], v[146:147] neg_lo:[1,0,0] neg_hi:[1,0,0]
    v_pk_fma_f32 v[150:151], v[26:27], v[158:159], v[150:151]
    v_pk_add_f32 v[176:177], v[144:145], v[146:147]
    v_pk_add_f32 v[178:179], v[148:149], v[150:151]
    v_pk_add_f32 v[180:181], v[144:145], v[146:147] neg_lo:[0,1] neg_hi:[0,1]
    v_pk_add_f32 v[182:183], v[148:149], v[150:151] neg_lo:[0,1] neg_hi:[0,1]
    v_pk_add_f32 v[168:169], v[176:177], v[176:177] op_sel:[0,1] op_sel_hi:[0,1] neg_hi:[0,1]
    v_pk_add_f32 v[170:171], v[178:179], v[178:179] op_sel:[0,1] op_sel_hi:[0,1] neg_hi:[1,0]
    v_pk_add_f32 v[172:173], v[180:181], v[182:183] op_sel:[0,1] op_sel_hi:[0,1] neg_hi:[0,1]
    v_pk_add_f32 v[174:175], v[182:183], v[180:181] op_sel:[0,1] op_sel_hi:[0,1] neg_lo:[0,1] neg_hi:[1,1]
    s_cbranch_scc1 L_nsp_47
    s_mov_b64 exec, s[40:41]
    v_mov_b32 v168, v169
    v_mov_b32 v170, 0
    v_mov_b32 v172, v180
    v_sub_f32 v174, 0, v181
    v_fma_f32 v173, s64, v183, v28
    v_fma_f32 v169, -s64, v183, v28
    v_fma_f32 v175, -s64, v179, -v30
    v_fma_f32 v171, -s64, v179, v30
    s_mov_b64 exec, -1
L_nsp_47:
    v_cvt_pk_bf16_f32 v193, v160, v168
    v_cvt_pk_bf16_f32 v197, v162, v170
    v_cvt_pk_bf16_f32 v201, v165, v173
    v_cvt_pk_bf16_f32 v205, v167, v175
    v_cvt_pk_bf16_f32 v209, v164, v172
    v_cvt_pk_bf16_f32 v213, v166, v174
    v_cvt_pk_bf16_f32 v217, v161, v169
    v_cvt_pk_bf16_f32 v221, v163, v171
    v_pk_mul_f32 v[32:33], v[32:33], v[132:133] op_sel_hi:[1,0]
    v_pk_mul_f32 v[34:35], v[34:35], v[132:133] op_sel_hi:[1,0]
    v_pk_mul_f32 v[36:37], v[36:37], v[132:133] op_sel_hi:[1,0]
    v_pk_mul_f32 v[38:39], v[38:39], v[132:133] op_sel_hi:[1,0]
    v_pk_mul_f32 v[144:145], v[32:33], v[152:153]
    v_pk_mul_f32 v[148:149], v[36:37], v[152:153]
    v_pk_mul_f32 v[146:147], v[34:35], v[154:155]
    v_pk_mul_f32 v[150:151], v[38:39], v[154:155]
    v_pk_fma_f32 v[144:145], v[36:37], v[156:157], v[144:145] neg_lo:[1,0,0] neg_hi:[1,0,0]
    v_pk_fma_f32 v[148:149], v[32:33], v[156:157], v[148:149]
    v_pk_fma_f32 v[146:147], v[38:39], v[158:159], v[146:147] neg_lo:[1,0,0] neg_hi:[1,0,0]
    v_pk_fma_f32 v[150:151], v[34:35], v[158:159], v[150:151]
    v_pk_add_f32 v[176:177], v[144:145], v[146:147]
    v_pk_add_f32 v[178:179], v[148:149], v[150:151]
    v_pk_add_f32 v[180:181], v[144:145], v[146:147] neg_lo:[0,1] neg_hi:[0,1]
    v_pk_add_f32 v[182:183], v[148:149], v[150:151] neg_lo:[0,1] neg_hi:[0,1]
    v_pk_add_f32 v[160:161], v[176:177], v[176:177] op_sel:[0,1] op_sel_hi:[0,1] neg_hi:[0,1]
    v_pk_add_f32 v[162:163], v[178:179], v[178:179] op_sel:[0,1] op_sel_hi:[0,1] neg_hi:[1,0]
    v_pk_add_f32 v[164:165], v[180:181], v[182:183] op_sel:[0,1] op_sel_hi:[0,1] neg_hi:[0,1]
    v_pk_add_f32 v[166:167], v[182:183], v[180:181] op_sel:[0,1] op_sel_hi:[0,1] neg_lo:[0,1] neg_hi:[1,1]
    s_cbranch_scc1 L_nsp_48
    s_mov_b64 exec, s[40:41]
    v_mov_b32 v160, v161
    v_mov_b32 v162, 0
    v_mov_b32 v164, v180
    v_sub_f32 v166, 0, v181
    v_fma_f32 v165, s64, v183, v36
    v_fma_f32 v161, -s64, v183, v36
    v_fma_f32 v167, -s64, v179, -v38
    v_fma_f32 v163, -s64, v179, v38
    s_mov_b64 exec, -1
L_nsp_48:
    v_pk_mul_f32 v[40:41], v[40:41], v[132:133] op_sel:[0,1] op_sel_hi:[1,1]
    v_pk_mul_f32 v[42:43], v[42:43], v[132:133] op_sel:[0,1] op_sel_hi:[1,1]
    v_pk_mul_f32 v[44:45], v[44:45], v[132:133] op_sel:[0,1] op_sel_hi:[1,1]
    v_pk_mul_f32 v[46:47], v[46:47], v[132:133] op_sel:[0,1] op_sel_hi:[1,1]
    v_pk_mul_f32 v[144:145], v[40:41], v[152:153]
    v_pk_mul_f32 v[148:149], v[44:45], v[152:153]
    v_pk_mul_f32 v[146:147], v[42:43], v[154:155]
    v_pk_mul_f32 v[150:151], v[46:47], v[154:155]
    v_pk_fma_f32 v[144:145], v[44:45], v[156:157], v[144:145] neg_lo:[1,0,0] neg_hi:[1,0,0]
    v_pk_fma_f32 v[148:149], v[40:41], v[156:157], v[148:149]
    v_pk_fma_f32 v[146:147], v[46:47], v[158:159], v[146:147] neg_lo:[1,0,0] neg_hi:[1,0,0]
    v_pk_fma_f32 v[150:151], v[42:43], v[158:159], v[150:151]
    v_pk_add_f32 v[176:177], v[144:145], v[146:147]
    v_pk_add_f32 v[178:179], v[148:149], v[150:151]
    v_pk_add_f32 v[180:181], v[144:145], v[146:147] neg_lo:[0,1] neg_hi:[0,1]
    v_pk_add_f32 v[182:183], v[148:149], v[150:151] neg_lo:[0,1] neg_hi:[0,1]
    v_pk_add_f32 v[168:169], v[176:177], v[176:177] op_sel:[0,1] op_sel_hi:[0,1] neg_hi:[0,1]
    v_pk_add_f32 v[170:171], v[178:179], v[178:179] op_sel:[0,1] op_sel_hi:[0,1] neg_hi:[1,0]
    v_pk_add_f32 v[172:173], v[180:181], v[182:183] op_sel:[0,1] op_sel_hi:[0,1] neg_hi:[0,1]
    v_pk_add_f32 v[174:175], v[182:183], v[180:181] op_sel:[0,1] op_sel_hi:[0,1] neg_lo:[0,1] neg_hi:[1,1]
    s_cbranch_scc1 L_nsp_49
    s_mov_b64 exec, s[40:41]
    v_mov_b32 v168, v169
    v_mov_b32 v170, 0
    v_mov_b32 v172, v180
    v_sub_f32 v174, 0, v181
    v_fma_f32 v173, s64, v183, v44
    v_fma_f32 v169, -s64, v183, v44
    v_fma_f32 v175, -s64, v179, -v46
    v_fma_f32 v171, -s64, v179, v46
    s_mov_b64 exec, -1
L_nsp_49:
    v_cvt_pk_bf16_f32 v194, v160, v168
    v_cvt_pk_bf16_f32 v198, v162, v170
    v_cvt_pk_bf16_f32 v202, v165, v173
    v_cvt_pk_bf16_f32 v206, v167, v175
    v_cvt_pk_bf16_f32 v210, v164, v172
    v_cvt_pk_bf16_f32 v214, v166, v174
    v_cvt_pk_bf16_f32 v218, v161, v169
    v_cvt_pk_bf16_f32 v222, v163, v171
    v_pk_mul_f32 v[48:49], v[48:49], v[134:135] op_sel_hi:[1,0]
    v_pk_mul_f32 v[50:51], v[50:51], v[134:135] op_sel_hi:[1,0]
    v_pk_mul_f32 v[52:53], v[52:53], v[134:135] op_sel_hi:[1,0]
    v_pk_mul_f32 v[54:55], v[54:55], v[134:135] op_sel_hi:[1,0]
    v_pk_mul_f32 v[144:145], v[48:49], v[152:153]
    v_pk_mul_f32 v[148:149], v[52:53], v[152:153]
    v_pk_mul_f32 v[146:147], v[50:51], v[154:155]
    v_pk_mul_f32 v[150:151], v[54:55], v[154:155]
    v_pk_fma_f32 v[144:145], v[52:53], v[156:157], v[144:145] neg_lo:[1,0,0] neg_hi:[1,0,0]
    v_pk_fma_f32 v[148:149], v[48:49], v[156:157], v[148:149]
    v_pk_fma_f32 v[146:147], v[54:55], v[158:159], v[146:147] neg_lo:[1,0,0] neg_hi:[1,0,0]
    v_pk_fma_f32 v[150:151], v[50:51], v[158:159], v[150:151]
    v_pk_add_f32 v[176:177], v[144:145], v[146:147]
    v_pk_add_f32 v[178:179], v[148:149], v[150:151]
    v_pk_add_f32 v[180:181], v[144:145], v[146:147] neg_lo:[0,1] neg_hi:[0,1]
    v_pk_add_f32 v[182:183], v[148:149], v[150:151] neg_lo:[0,1] neg_hi:[0,1]
    v_pk_add_f32 v[160:161], v[176:177], v[176:177] op_sel:[0,1] op_sel_hi:[0,1] neg_hi:[0,1]
    v_pk_add_f32 v[162:163], v[178:179], v[178:179] op_sel:[0,1] op_sel_hi:[0,1] neg_hi:[1,0]
    v_pk_add_f32 v[164:165], v[180:181], v[182:183] op_sel:[0,1] op_sel_hi:[0,1] neg_hi:[0,1]
    v_pk_add_f32 v[166:167], v[182:183], v[180:181] op_sel:[0,1] op_sel_hi:[0,1] neg_lo:[0,1] neg_hi:[1,1]
    s_cbranch_scc1 L_nsp_50
    s_mov_b64 exec, s[40:41]
    v_mov_b32 v160, v161
    v_mov_b32 v162, 0
    v_mov_b32 v164, v180
    v_sub_f32 v166, 0, v181
    v_fma_f32 v165, s64, v183, v52
    v_fma_f32 v161, -s64, v183, v52
    v_fma_f32 v167, -s64, v179, -v54
    v_fma_f32 v163, -s64, v179, v54
    s_mov_b64 exec, -1
L_nsp_50:
    v_pk_mul_f32 v[56:57], v[56:57], v[134:135] op_sel:[0,1] op_sel_hi:[1,1]
    v_pk_mul_f32 v[58:59], v[58:59], v[134:135] op_sel:[0,1] op_sel_hi:[1,1]
    v_pk_mul_f32 v[60:61], v[60:61], v[134:135] op_sel:[0,1] op_sel_hi:[1,1]
    v_pk_mul_f32 v[62:63], v[62:63], v[134:135] op_sel:[0,1] op_sel_hi:[1,1]
    v_pk_mul_f32 v[144:145], v[56:57], v[152:153]
    v_pk_mul_f32 v[148:149], v[60:61], v[152:153]
    v_pk_mul_f32 v[146:147], v[58:59], v[154:155]
    v_pk_mul_f32 v[150:151], v[62:63], v[154:155]
    v_pk_fma_f32 v[144:145], v[60:61], v[156:157], v[144:145] neg_lo:[1,0,0] neg_hi:[1,0,0]
    v_pk_fma_f32 v[148:149], v[56:57], v[156:157], v[148:149]
    v_pk_fma_f32 v[146:147], v[62:63], v[158:159], v[146:147] neg_lo:[1,0,0] neg_hi:[1,0,0]
    v_pk_fma_f32 v[150:151], v[58:59], v[158:159], v[150:151]
    v_pk_add_f32 v[176:177], v[144:145], v[146:147]
    v_pk_add_f32 v[178:179], v[148:149], v[150:151]
    v_pk_add_f32 v[180:181], v[144:145], v[146:147] neg_lo:[0,1] neg_hi:[0,1]
    v_pk_add_f32 v[182:183], v[148:149], v[150:151] neg_lo:[0,1] neg_hi:[0,1]
    v_pk_add_f32 v[168:169], v[176:177], v[176:177] op_sel:[0,1] op_sel_hi:[0,1] neg_hi:[0,1]
    v_pk_add_f32 v[170:171], v[178:179], v[178:179] op_sel:[0,1] op_sel_hi:[0,1] neg_hi:[1,0]
    v_pk_add_f32 v[172:173], v[180:181], v[182:183] op_sel:[0,1] op_sel_hi:[0,1] neg_hi:[0,1]
    v_pk_add_f32 v[174:175], v[182:183], v[180:181] op_sel:[0,1] op_sel_hi:[0,1] neg_lo:[0,1] neg_hi:[1,1]
    s_cbranch_scc1 L_nsp_51
    s_mov_b64 exec, s[40:41]
    v_mov_b32 v168, v169
    v_mov_b32 v170, 0
    v_mov_b32 v172, v180
    v_sub_f32 v174, 0, v181
    v_fma_f32 v173, s64, v183, v60
    v_fma_f32 v169, -s64, v183, v60
    v_fma_f32 v175, -s64, v179, -v62
    v_fma_f32 v171, -s64, v179, v62
    s_mov_b64 exec, -1
L_nsp_51:
    v_cvt_pk_bf16_f32 v195, v160, v168
    v_cvt_pk_bf16_f32 v199, v162, v170
    v_cvt_pk_bf16_f32 v203, v165, v173
    v_cvt_pk_bf16_f32 v207, v167, v175
    v_cvt_pk_bf16_f32 v211, v164, v172
    v_cvt_pk_bf16_f32 v215, v166, v174
    v_cvt_pk_bf16_f32 v219, v161, v169
    v_cvt_pk_bf16_f32 v223, v163, v171
    s_nop 1
    v_mfma_f32_16x16x32_bf16 v[0:3], v[228:231], v[192:195], 0
    v_mfma_f32_16x16x32_bf16 v[4:7], v[228:231], v[196:199], 0
    v_mfma_f32_16x16x32_bf16 v[0:3], v[236:239], v[196:199], v[0:3]
    v_mfma_f32_16x16x32_bf16 v[4:7], v[244:247], v[192:195], v[4:7]
    v_mfma_f32_16x16x32_bf16 v[8:11], v[232:235], v[192:195], 0
    v_mfma_f32_16x16x32_bf16 v[12:15], v[232:235], v[196:199], 0
    v_mfma_f32_16x16x32_bf16 v[8:11], v[240:243], v[196:199], v[8:11]
    v_mfma_f32_16x16x32_bf16 v[12:15], v[248:251], v[192:195], v[12:15]
    v_mfma_f32_16x16x32_bf16 v[16:19], v[228:231], v[200:203], 0
    v_mfma_f32_16x16x32_bf16 v[20:23], v[228:231], v[204:207], 0
    v_mfma_f32_16x16x32_bf16 v[16:19], v[236:239], v[204:207], v[16:19]
    v_mfma_f32_16x16x32_bf16 v[20:23], v[244:247], v[200:203], v[20:23]
    v_mfma_f32_16x16x32_bf16 v[24:27], v[232:235], v[200:203], 0
    v_mfma_f32_16x16x32_bf16 v[28:31], v[232:235], v[204:207], 0
    v_mfma_f32_16x16x32_bf16 v[24:27], v[240:243], v[204:207], v[24:27]
    v_mfma_f32_16x16x32_bf16 v[28:31], v[248:251], v[200:203], v[28:31]
    v_mfma_f32_16x16x32_bf16 v[32:35], v[228:231], v[208:211], 0
    v_mfma_f32_16x16x32_bf16 v[36:39], v[228:231], v[212:215], 0
    v_mfma_f32_16x16x32_bf16 v[32:35], v[236:239], v[212:215], v[32:35]
    v_mfma_f32_16x16x32_bf16 v[36:39], v[244:247], v[208:211], v[36:39]
    v_mfma_f32_16x16x32_bf16 v[40:43], v[232:235], v[208:211], 0
    v_mfma_f32_16x16x32_bf16 v[44:47], v[232:235], v[212:215], 0
    v_mfma_f32_16x16x32_bf16 v[40:43], v[240:243], v[212:215], v[40:43]
    v_mfma_f32_16x16x32_bf16 v[44:47], v[248:251], v[208:211], v[44:47]
    v_mfma_f32_16x16x32_bf16 v[48:51], v[228:231], v[216:219], 0
    v_mfma_f32_16x16x32_bf16 v[52:55], v[228:231], v[220:223], 0
    v_mfma_f32_16x16x32_bf16 v[48:51], v[236:239], v[220:223], v[48:51]
    v_mfma_f32_16x16x32_bf16 v[52:55], v[244:247], v[216:219], v[52:55]
    v_mfma_f32_16x16x32_bf16 v[56:59], v[232:235], v[216:219], 0
    v_mfma_f32_16x16x32_bf16 v[60:63], v[232:235], v[220:223], 0
    v_mfma_f32_16x16x32_bf16 v[56:59], v[240:243], v[220:223], v[56:59]
    v_mfma_f32_16x16x32_bf16 v[60:63], v[248:251], v[216:219], v[60:63]
    v_pk_mul_f32 v[64:65], v[64:65], v[136:137] op_sel_hi:[1,0]
    v_pk_mul_f32 v[66:67], v[66:67], v[136:137] op_sel_hi:[1,0]
    v_pk_mul_f32 v[68:69], v[68:69], v[136:137] op_sel_hi:[1,0]
    v_pk_mul_f32 v[70:71], v[70:71], v[136:137] op_sel_hi:[1,0]
    v_pk_mul_f32 v[144:145], v[64:65], v[152:153]
    v_pk_mul_f32 v[148:149], v[68:69], v[152:153]
    v_pk_mul_f32 v[146:147], v[66:67], v[154:155]
    v_pk_mul_f32 v[150:151], v[70:71], v[154:155]
    v_pk_fma_f32 v[144:145], v[68:69], v[156:157], v[144:145] neg_lo:[1,0,0] neg_hi:[1,0,0]
    v_pk_fma_f32 v[148:149], v[64:65], v[156:157], v[148:149]
    v_pk_fma_f32 v[146:147], v[70:71], v[158:159], v[146:147] neg_lo:[1,0,0] neg_hi:[1,0,0]
    v_pk_fma_f32 v[150:151], v[66:67], v[158:159], v[150:151]
    v_pk_add_f32 v[176:177], v[144:145], v[146:147]
    v_pk_add_f32 v[178:179], v[148:149], v[150:151]
    v_pk_add_f32 v[180:181], v[144:145], v[146:147] neg_lo:[0,1] neg_hi:[0,1]
    v_pk_add_f32 v[182:183], v[148:149], v[150:151] neg_lo:[0,1] neg_hi:[0,1]
    v_pk_add_f32 v[160:161], v[176:177], v[176:177] op_sel:[0,1] op_sel_hi:[0,1] neg_hi:[0,1]
    v_pk_add_f32 v[162:163], v[178:179], v[178:179] op_sel:[0,1] op_sel_hi:[0,1] neg_hi:[1,0]
    v_pk_add_f32 v[164:165], v[180:181], v[182:183] op_sel:[0,1] op_sel_hi:[0,1] neg_hi:[0,1]
    v_pk_add_f32 v[166:167], v[182:183], v[180:181] op_sel:[0,1] op_sel_hi:[0,1] neg_lo:[0,1] neg_hi:[1,1]
    s_cbranch_scc1 L_nsp_52
    s_mov_b64 exec, s[40:41]
    v_mov_b32 v160, v161
    v_mov_b32 v162, 0
    v_mov_b32 v164, v180
    v_sub_f32 v166, 0, v181
    v_fma_f32 v165, s64, v183, v68
    v_fma_f32 v161, -s64, v183, v68
    v_fma_f32 v167, -s64, v179, -v70
    v_fma_f32 v163, -s64, v179, v70
    s_mov_b64 exec, -1
L_nsp_52:
    v_pk_mul_f32 v[72:73], v[72:73], v[136:137] op_sel:[0,1] op_sel_hi:[1,1]
    v_pk_mul_f32 v[74:75], v[74:75], v[136:137] op_sel:[0,1] op_sel_hi:[1,1]
    v_pk_mul_f32 v[76:77], v[76:77], v[136:137] op_sel:[0,1] op_sel_hi:[1,1]
    v_pk_mul_f32 v[78:79], v[78:79], v[136:137] op_sel:[0,1] op_sel_hi:[1,1]
    v_pk_mul_f32 v[144:145], v[72:73], v[152:153]
    v_pk_mul_f32 v[148:149], v[76:77], v[152:153]
    v_pk_mul_f32 v[146:147], v[74:75], v[154:155]
    v_pk_mul_f32 v[150:151], v[78:79], v[154:155]
    v_pk_fma_f32 v[144:145], v[76:77], v[156:157], v[144:145] neg_lo:[1,0,0] neg_hi:[1,0,0]
    v_pk_fma_f32 v[148:149], v[72:73], v[156:157], v[148:149]
    v_pk_fma_f32 v[146:147], v[78:79], v[158:159], v[146:147] neg_lo:[1,0,0] neg_hi:[1,0,0]
    v_pk_fma_f32 v[150:151], v[74:75], v[158:159], v[150:151]
    v_pk_add_f32 v[176:177], v[144:145], v[146:147]
    v_pk_add_f32 v[178:179], v[148:149], v[150:151]
    v_pk_add_f32 v[180:181], v[144:145], v[146:147] neg_lo:[0,1] neg_hi:[0,1]
    v_pk_add_f32 v[182:183], v[148:149], v[150:151] neg_lo:[0,1] neg_hi:[0,1]
    v_pk_add_f32 v[168:169], v[176:177], v[176:177] op_sel:[0,1] op_sel_hi:[0,1] neg_hi:[0,1]
    v_pk_add_f32 v[170:171], v[178:179], v[178:179] op_sel:[0,1] op_sel_hi:[0,1] neg_hi:[1,0]
    v_pk_add_f32 v[172:173], v[180:181], v[182:183] op_sel:[0,1] op_sel_hi:[0,1] neg_hi:[0,1]
    v_pk_add_f32 v[174:175], v[182:183], v[180:181] op_sel:[0,1] op_sel_hi:[0,1] neg_lo:[0,1] neg_hi:[1,1]
    s_cbranch_scc1 L_nsp_53
    s_mov_b64 exec, s[40:41]
    v_mov_b32 v168, v169
    v_mov_b32 v170, 0
    v_mov_b32 v172, v180
    v_sub_f32 v174, 0, v181
    v_fma_f32 v173, s64, v183, v76
    v_fma_f32 v169, -s64, v183, v76
    v_fma_f32 v175, -s64, v179, -v78
    v_fma_f32 v171, -s64, v179, v78
    s_mov_b64 exec, -1
L_nsp_53:
    v_cvt_pk_bf16_f32 v192, v160, v168
    v_cvt_pk_bf16_f32 v196, v162, v170
    v_cvt_pk_bf16_f32 v200, v165, v173
    v_cvt_pk_bf16_f32 v204, v167, v175
    v_cvt_pk_bf16_f32 v208, v164, v172
    v_cvt_pk_bf16_f32 v212, v166, v174
    v_cvt_pk_bf16_f32 v216, v161, v169
    v_cvt_pk_bf16_f32 v220, v163, v171
    v_pk_mul_f32 v[80:81], v[80:81], v[138:139] op_sel_hi:[1,0]
    v_pk_mul_f32 v[82:83], v[82:83], v[138:139] op_sel_hi:[1,0]
    v_pk_mul_f32 v[84:85], v[84:85], v[138:139] op_sel_hi:[1,0]
    v_pk_mul_f32 v[86:87], v[86:87], v[138:139] op_sel_hi:[1,0]
    v_pk_mul_f32 v[144:145], v[80:81], v[152:153]
    v_pk_mul_f32 v[148:149], v[84:85], v[152:153]
    v_pk_mul_f32 v[146:147], v[82:83], v[154:155]
    v_pk_mul_f32 v[150:151], v[86:87], v[154:155]
    v_pk_fma_f32 v[144:145], v[84:85], v[156:157], v[144:145] neg_lo:[1,0,0] neg_hi:[1,0,0]
    v_pk_fma_f32 v[148:149], v[80:81], v[156:157], v[148:149]
    v_pk_fma_f32 v[146:147], v[86:87], v[158:159], v[146:147] neg_lo:[1,0,0] neg_hi:[1,0,0]
    v_pk_fma_f32 v[150:151], v[82:83], v[158:159], v[150:151]
    v_pk_add_f32 v[176:177], v[144:145], v[146:147]
    v_pk_add_f32 v[178:179], v[148:149], v[150:151]
    v_pk_add_f32 v[180:181], v[144:145], v[146:147] neg_lo:[0,1] neg_hi:[0,1]
    v_pk_add_f32 v[182:183], v[148:149], v[150:151] neg_lo:[0,1] neg_hi:[0,1]
    v_pk_add_f32 v[160:161], v[176:177], v[176:177] op_sel:[0,1] op_sel_hi:[0,1] neg_hi:[0,1]
    v_pk_add_f32 v[162:163], v[178:179], v[178:179] op_sel:[0,1] op_sel_hi:[0,1] neg_hi:[1,0]
    v_pk_add_f32 v[164:165], v[180:181], v[182:183] op_sel:[0,1] op_sel_hi:[0,1] neg_hi:[0,1]
    v_pk_add_f32 v[166:167], v[182:183], v[180:181] op_sel:[0,1] op_sel_hi:[0,1] neg_lo:[0,1] neg_hi:[1,1]
    s_cbranch_scc1 L_nsp_54
    s_mov_b64 exec, s[40:41]
    v_mov_b32 v160, v161
    v_mov_b32 v162, 0
    v_mov_b32 v164, v180
    v_sub_f32 v166, 0, v181
    v_fma_f32 v165, s64, v183, v84
    v_fma_f32 v161, -s64, v183, v84
    v_fma_f32 v167, -s64, v179, -v86
    v_fma_f32 v163, -s64, v179, v86
    s_mov_b64 exec, -1
L_nsp_54:
    v_pk_mul_f32 v[88:89], v[88:89], v[138:139] op_sel:[0,1] op_sel_hi:[1,1]
    v_pk_mul_f32 v[90:91], v[90:91], v[138:139] op_sel:[0,1] op_sel_hi:[1,1]
    v_pk_mul_f32 v[92:93], v[92:93], v[138:139] op_sel:[0,1] op_sel_hi:[1,1]
    v_pk_mul_f32 v[94:95], v[94:95], v[138:139] op_sel:[0,1] op_sel_hi:[1,1]
    v_pk_mul_f32 v[144:145], v[88:89], v[152:153]
    v_pk_mul_f32 v[148:149], v[92:93], v[152:153]
    v_pk_mul_f32 v[146:147], v[90:91], v[154:155]
    v_pk_mul_f32 v[150:151], v[94:95], v[154:155]
    v_pk_fma_f32 v[144:145], v[92:93], v[156:157], v[144:145] neg_lo:[1,0,0] neg_hi:[1,0,0]
    v_pk_fma_f32 v[148:149], v[88:89], v[156:157], v[148:149]
    v_pk_fma_f32 v[146:147], v[94:95], v[158:159], v[146:147] neg_lo:[1,0,0] neg_hi:[1,0,0]
    v_pk_fma_f32 v[150:151], v[90:91], v[158:159], v[150:151]
    v_pk_add_f32 v[176:177], v[144:145], v[146:147]
    v_pk_add_f32 v[178:179], v[148:149], v[150:151]
    v_pk_add_f32 v[180:181], v[144:145], v[146:147] neg_lo:[0,1] neg_hi:[0,1]
    v_pk_add_f32 v[182:183], v[148:149], v[150:151] neg_lo:[0,1] neg_hi:[0,1]
    v_pk_add_f32 v[168:169], v[176:177], v[176:177] op_sel:[0,1] op_sel_hi:[0,1] neg_hi:[0,1]
    v_pk_add_f32 v[170:171], v[178:179], v[178:179] op_sel:[0,1] op_sel_hi:[0,1] neg_hi:[1,0]
    v_pk_add_f32 v[172:173], v[180:181], v[182:183] op_sel:[0,1] op_sel_hi:[0,1] neg_hi:[0,1]
    v_pk_add_f32 v[174:175], v[182:183], v[180:181] op_sel:[0,1] op_sel_hi:[0,1] neg_lo:[0,1] neg_hi:[1,1]
    s_cbranch_scc1 L_nsp_55
    s_mov_b64 exec, s[40:41]
    v_mov_b32 v168, v169
    v_mov_b32 v170, 0
    v_mov_b32 v172, v180
    v_sub_f32 v174, 0, v181
    v_fma_f32 v173, s64, v183, v92
    v_fma_f32 v169, -s64, v183, v92
    v_fma_f32 v175, -s64, v179, -v94
    v_fma_f32 v171, -s64, v179, v94
    s_mov_b64 exec, -1
L_nsp_55:
    v_cvt_pk_bf16_f32 v193, v160, v168
    v_cvt_pk_bf16_f32 v197, v162, v170
    v_cvt_pk_bf16_f32 v201, v165, v173
    v_cvt_pk_bf16_f32 v205, v167, v175
    v_cvt_pk_bf16_f32 v209, v164, v172
    v_cvt_pk_bf16_f32 v213, v166, v174
    v_cvt_pk_bf16_f32 v217, v161, v169
    v_cvt_pk_bf16_f32 v221, v163, v171
    v_pk_mul_f32 v[96:97], v[96:97], v[140:141] op_sel_hi:[1,0]
    v_pk_mul_f32 v[98:99], v[98:99], v[140:141] op_sel_hi:[1,0]
    v_pk_mul_f32 v[100:101], v[100:101], v[140:141] op_sel_hi:[1,0]
    v_pk_mul_f32 v[102:103], v[102:103], v[140:141] op_sel_hi:[1,0]
    v_pk_mul_f32 v[144:145], v[96:97], v[152:153]
    v_pk_mul_f32 v[148:149], v[100:101], v[152:153]
    v_pk_mul_f32 v[146:147], v[98:99], v[154:155]
    v_pk_mul_f32 v[150:151], v[102:103], v[154:155]
    v_pk_fma_f32 v[144:145], v[100:101], v[156:157], v[144:145] neg_lo:[1,0,0] neg_hi:[1,0,0]
    v_pk_fma_f32 v[148:149], v[96:97], v[156:157], v[148:149]
    v_pk_fma_f32 v[146:147], v[102:103], v[158:159], v[146:147] neg_lo:[1,0,0] neg_hi:[1,0,0]
    v_pk_fma_f32 v[150:151], v[98:99], v[158:159], v[150:151]
    v_pk_add_f32 v[176:177], v[144:145], v[146:147]
    v_pk_add_f32 v[178:179], v[148:149], v[150:151]
    v_pk_add_f32 v[180:181], v[144:145], v[146:147] neg_lo:[0,1] neg_hi:[0,1]
    v_pk_add_f32 v[182:183], v[148:149], v[150:151] neg_lo:[0,1] neg_hi:[0,1]
    v_pk_add_f32 v[160:161], v[176:177], v[176:177] op_sel:[0,1] op_sel_hi:[0,1] neg_hi:[0,1]
    v_pk_add_f32 v[162:163], v[178:179], v[178:179] op_sel:[0,1] op_sel_hi:[0,1] neg_hi:[1,0]
    v_pk_add_f32 v[164:165], v[180:181], v[182:183] op_sel:[0,1] op_sel_hi:[0,1] neg_hi:[0,1]
    v_pk_add_f32 v[166:167], v[182:183], v[180:181] op_sel:[0,1] op_sel_hi:[0,1] neg_lo:[0,1] neg_hi:[1,1]
    s_cbranch_scc1 L_nsp_56
    s_mov_b64 exec, s[40:41]
    v_mov_b32 v160, v161
    v_mov_b32 v162, 0
    v_mov_b32 v164, v180
    v_sub_f32 v166, 0, v181
    v_fma_f32 v165, s64, v183, v100
    v_fma_f32 v161, -s64, v183, v100
    v_fma_f32 v167, -s64, v179, -v102
    v_fma_f32 v163, -s64, v179, v102
    s_mov_b64 exec, -1
L_nsp_56:
    v_pk_mul_f32 v[104:105], v[104:105], v[140:141] op_sel:[0,1] op_sel_hi:[1,1]
    v_pk_mul_f32 v[106:107], v[106:107], v[140:141] op_sel:[0,1] op_sel_hi:[1,1]
    v_pk_mul_f32 v[108:109], v[108:109], v[140:141] op_sel:[0,1] op_sel_hi:[1,1]
    v_pk_mul_f32 v[110:111], v[110:111], v[140:141] op_sel:[0,1] op_sel_hi:[1,1]
    v_pk_mul_f32 v[144:145], v[104:105], v[152:153]
    v_pk_mul_f32 v[148:149], v[108:109], v[152:153]
    v_pk_mul_f32 v[146:147], v[106:107], v[154:155]
    v_pk_mul_f32 v[150:151], v[110:111], v[154:155]
    v_pk_fma_f32 v[144:145], v[108:109], v[156:157], v[144:145] neg_lo:[1,0,0] neg_hi:[1,0,0]
    v_pk_fma_f32 v[148:149], v[104:105], v[156:157], v[148:149]
    v_pk_fma_f32 v[146:147], v[110:111], v[158:159], v[146:147] neg_lo:[1,0,0] neg_hi:[1,0,0]
    v_pk_fma_f32 v[150:151], v[106:107], v[158:159], v[150:151]
    v_pk_add_f32 v[176:177], v[144:145], v[146:147]
    v_pk_add_f32 v[178:179], v[148:149], v[150:151]
    v_pk_add_f32 v[180:181], v[144:145], v[146:147] neg_lo:[0,1] neg_hi:[0,1]
    v_pk_add_f32 v[182:183], v[148:149], v[150:151] neg_lo:[0,1] neg_hi:[0,1]
    v_pk_add_f32 v[168:169], v[176:177], v[176:177] op_sel:[0,1] op_sel_hi:[0,1] neg_hi:[0,1]
    v_pk_add_f32 v[170:171], v[178:179], v[178:179] op_sel:[0,1] op_sel_hi:[0,1] neg_hi:[1,0]
    v_pk_add_f32 v[172:173], v[180:181], v[182:183] op_sel:[0,1] op_sel_hi:[0,1] neg_hi:[0,1]
    v_pk_add_f32 v[174:175], v[182:183], v[180:181] op_sel:[0,1] op_sel_hi:[0,1] neg_lo:[0,1] neg_hi:[1,1]
    s_cbranch_scc1 L_nsp_57
    s_mov_b64 exec, s[40:41]
    v_mov_b32 v168, v169
    v_mov_b32 v170, 0
    v_mov_b32 v172, v180
    v_sub_f32 v174, 0, v181
    v_fma_f32 v173, s64, v183, v108
    v_fma_f32 v169, -s64, v183, v108
    v_fma_f32 v175, -s64, v179, -v110
    v_fma_f32 v171, -s64, v179, v110
    s_mov_b64 exec, -1
L_nsp_57:
    v_cvt_pk_bf16_f32 v194, v160, v168
    v_cvt_pk_bf16_f32 v198, v162, v170
    v_cvt_pk_bf16_f32 v202, v165, v173
    v_cvt_pk_bf16_f32 v206, v167, v175
    v_cvt_pk_bf16_f32 v210, v164, v172
    v_cvt_pk_bf16_f32 v214, v166, v174
    v_cvt_pk_bf16_f32 v218, v161, v169
    v_cvt_pk_bf16_f32 v222, v163, v171
    v_pk_mul_f32 v[112:113], v[112:113], v[142:143] op_sel_hi:[1,0]
    v_pk_mul_f32 v[114:115], v[114:115], v[142:143] op_sel_hi:[1,0]
    v_pk_mul_f32 v[116:117], v[116:117], v[142:143] op_sel_hi:[1,0]
    v_pk_mul_f32 v[118:119], v[118:119], v[142:143] op_sel_hi:[1,0]
    v_pk_mul_f32 v[144:145], v[112:113], v[152:153]
    v_pk_mul_f32 v[148:149], v[116:117], v[152:153]
    v_pk_mul_f32 v[146:147], v[114:115], v[154:155]
    v_pk_mul_f32 v[150:151], v[118:119], v[154:155]
    v_pk_fma_f32 v[144:145], v[116:117], v[156:157], v[144:145] neg_lo:[1,0,0] neg_hi:[1,0,0]
    v_pk_fma_f32 v[148:149], v[112:113], v[156:157], v[148:149]
    v_pk_fma_f32 v[146:147], v[118:119], v[158:159], v[146:147] neg_lo:[1,0,0] neg_hi:[1,0,0]
    v_pk_fma_f32 v[150:151], v[114:115], v[158:159], v[150:151]
    v_pk_add_f32 v[176:177], v[144:145], v[146:147]
    v_pk_add_f32 v[178:179], v[148:149], v[150:151]
    v_pk_add_f32 v[180:181], v[144:145], v[146:147] neg_lo:[0,1] neg_hi:[0,1]
    v_pk_add_f32 v[182:183], v[148:149], v[150:151] neg_lo:[0,1] neg_hi:[0,1]
    v_pk_add_f32 v[160:161], v[176:177], v[176:177] op_sel:[0,1] op_sel_hi:[0,1] neg_hi:[0,1]
    v_pk_add_f32 v[162:163], v[178:179], v[178:179] op_sel:[0,1] op_sel_hi:[0,1] neg_hi:[1,0]
    v_pk_add_f32 v[164:165], v[180:181], v[182:183] op_sel:[0,1] op_sel_hi:[0,1] neg_hi:[0,1]
    v_pk_add_f32 v[166:167], v[182:183], v[180:181] op_sel:[0,1] op_sel_hi:[0,1] neg_lo:[0,1] neg_hi:[1,1]
    s_cbranch_scc1 L_nsp_58
    s_mov_b64 exec, s[40:41]
    v_mov_b32 v160, v161
    v_mov_b32 v162, 0
    v_mov_b32 v164, v180
    v_sub_f32 v166, 0, v181
    v_fma_f32 v165, s64, v183, v116
    v_fma_f32 v161, -s64, v183, v116
    v_fma_f32 v167, -s64, v179, -v118
    v_fma_f32 v163, -s64, v179, v118
    s_mov_b64 exec, -1
L_nsp_58:
    v_pk_mul_f32 v[120:121], v[120:121], v[142:143] op_sel:[0,1] op_sel_hi:[1,1]
    v_pk_mul_f32 v[122:123], v[122:123], v[142:143] op_sel:[0,1] op_sel_hi:[1,1]
    v_pk_mul_f32 v[124:125], v[124:125], v[142:143] op_sel:[0,1] op_sel_hi:[1,1]
    v_pk_mul_f32 v[126:127], v[126:127], v[142:143] op_sel:[0,1] op_sel_hi:[1,1]
    v_pk_mul_f32 v[144:145], v[120:121], v[152:153]
    v_pk_mul_f32 v[148:149], v[124:125], v[152:153]
    v_pk_mul_f32 v[146:147], v[122:123], v[154:155]
    v_pk_mul_f32 v[150:151], v[126:127], v[154:155]
    v_pk_fma_f32 v[144:145], v[124:125], v[156:157], v[144:145] neg_lo:[1,0,0] neg_hi:[1,0,0]
    v_pk_fma_f32 v[148:149], v[120:121], v[156:157], v[148:149]
    v_pk_fma_f32 v[146:147], v[126:127], v[158:159], v[146:147] neg_lo:[1,0,0] neg_hi:[1,0,0]
    v_pk_fma_f32 v[150:151], v[122:123], v[158:159], v[150:151]
    v_pk_add_f32 v[176:177], v[144:145], v[146:147]
    v_pk_add_f32 v[178:179], v[148:149], v[150:151]
    v_pk_add_f32 v[180:181], v[144:145], v[146:147] neg_lo:[0,1] neg_hi:[0,1]
    v_pk_add_f32 v[182:183], v[148:149], v[150:151] neg_lo:[0,1] neg_hi:[0,1]
    v_pk_add_f32 v[168:169], v[176:177], v[176:177] op_sel:[0,1] op_sel_hi:[0,1] neg_hi:[0,1]
    v_pk_add_f32 v[170:171], v[178:179], v[178:179] op_sel:[0,1] op_sel_hi:[0,1] neg_hi:[1,0]
    v_pk_add_f32 v[172:173], v[180:181], v[182:183] op_sel:[0,1] op_sel_hi:[0,1] neg_hi:[0,1]
    v_pk_add_f32 v[174:175], v[182:183], v[180:181] op_sel:[0,1] op_sel_hi:[0,1] neg_lo:[0,1] neg_hi:[1,1]
    s_cbranch_scc1 L_nsp_59
    s_mov_b64 exec, s[40:41]
    v_mov_b32 v168, v169
    v_mov_b32 v170, 0
    v_mov_b32 v172, v180
    v_sub_f32 v174, 0, v181
    v_fma_f32 v173, s64, v183, v124
    v_fma_f32 v169, -s64, v183, v124
    v_fma_f32 v175, -s64, v179, -v126
    v_fma_f32 v171, -s64, v179, v126
    s_mov_b64 exec, -1
L_nsp_59:
    v_cvt_pk_bf16_f32 v195, v160, v168
    v_cvt_pk_bf16_f32 v199, v162, v170
    v_cvt_pk_bf16_f32 v203, v165, v173
    v_cvt_pk_bf16_f32 v207, v167, v175
    v_cvt_pk_bf16_f32 v211, v164, v172
    v_cvt_pk_bf16_f32 v215, v166, v174
    v_cvt_pk_bf16_f32 v219, v161, v169
    v_cvt_pk_bf16_f32 v223, v163, v171
    s_nop 1
    v_mfma_f32_16x16x32_bf16 v[64:67], v[228:231], v[192:195], 0
    v_mfma_f32_16x16x32_bf16 v[68:71], v[228:231], v[196:199], 0
    v_mfma_f32_16x16x32_bf16 v[64:67], v[236:239], v[196:199], v[64:67]
    v_mfma_f32_16x16x32_bf16 v[68:71], v[244:247], v[192:195], v[68:71]
    v_mfma_f32_16x16x32_bf16 v[72:75], v[232:235], v[192:195], 0
    v_mfma_f32_16x16x32_bf16 v[76:79], v[232:235], v[196:199], 0
    v_mfma_f32_16x16x32_bf16 v[72:75], v[240:243], v[196:199], v[72:75]
    v_mfma_f32_16x16x32_bf16 v[76:79], v[248:251], v[192:195], v[76:79]
    v_mfma_f32_16x16x32_bf16 v[80:83], v[228:231], v[200:203], 0
    v_mfma_f32_16x16x32_bf16 v[84:87], v[228:231], v[204:207], 0
    v_mfma_f32_16x16x32_bf16 v[80:83], v[236:239], v[204:207], v[80:83]
    v_mfma_f32_16x16x32_bf16 v[84:87], v[244:247], v[200:203], v[84:87]
    v_mfma_f32_16x16x32_bf16 v[88:91], v[232:235], v[200:203], 0
    v_cvt_pk_bf16_f32 v128, v0, v4
    v_cvt_pk_bf16_f32 v129, v64, v68
    s_add_u32 s63, s90, 0
    buffer_store_dwordx2 v[128:129], v253, s[20:23], s63 offen sc1
    v_mfma_f32_16x16x32_bf16 v[92:95], v[232:235], v[204:207], 0
    v_cvt_pk_bf16_f32 v130, v1, v5
    v_cvt_pk_bf16_f32 v131, v65, v69
    s_add_u32 s63, s90, 69632
    buffer_store_dwordx2 v[130:131], v253, s[20:23], s63 offen sc1
    v_mfma_f32_16x16x32_bf16 v[88:91], v[240:243], v[204:207], v[88:91]
    v_cvt_pk_bf16_f32 v132, v2, v6
    v_cvt_pk_bf16_f32 v133, v66, v70
    s_add_u32 s63, s90, 139264
    buffer_store_dwordx2 v[132:133], v253, s[20:23], s63 offen sc1
    v_mfma_f32_16x16x32_bf16 v[92:95], v[248:251], v[200:203], v[92:95]
    v_cvt_pk_bf16_f32 v134, v3, v7
    v_cvt_pk_bf16_f32 v135, v67, v71
    s_add_u32 s63, s90, 208896
    buffer_store_dwordx2 v[134:135], v253, s[20:23], s63 offen sc1
    v_cvt_pk_bf16_f32 v136, v8, v12
    v_cvt_pk_bf16_f32 v137, v72, v76
    s_add_u32 s63, s90, 1114112
    buffer_store_dwordx2 v[136:137], v253, s[20:23], s63 offen sc1
    v_cvt_pk_bf16_f32 v138, v9, v13
    v_cvt_pk_bf16_f32 v139, v73, v77
    s_add_u32 s63, s90, 1183744
    buffer_store_dwordx2 v[138:139], v253, s[20:23], s63 offen sc1
    v_cvt_pk_bf16_f32 v140, v10, v14
    v_cvt_pk_bf16_f32 v141, v74, v78
    s_add_u32 s63, s90, 1253376
    buffer_store_dwordx2 v[140:141], v253, s[20:23], s63 offen sc1
    v_cvt_pk_bf16_f32 v142, v11, v15
    v_cvt_pk_bf16_f32 v143, v75, v79
    s_add_u32 s63, s90, 1323008
    buffer_store_dwordx2 v[142:143], v253, s[20:23], s63 offen sc1
    v_mfma_f32_16x16x32_bf16 v[96:99], v[228:231], v[208:211], 0
    v_mfma_f32_16x16x32_bf16 v[100:103], v[228:231], v[212:215], 0
    v_mfma_f32_16x16x32_bf16 v[96:99], v[236:239], v[212:215], v[96:99]
    v_mfma_f32_16x16x32_bf16 v[100:103], v[244:247], v[208:211], v[100:103]
    v_mfma_f32_16x16x32_bf16 v[104:107], v[232:235], v[208:211], 0
    v_cvt_pk_bf16_f32 v144, v16, v20
    v_cvt_pk_bf16_f32 v145, v80, v84
    s_add_u32 s63, s90, 16384
    buffer_store_dwordx2 v[144:145], v253, s[20:23], s63 offen sc1
    v_mfma_f32_16x16x32_bf16 v[108:111], v[232:235], v[212:215], 0
    v_cvt_pk_bf16_f32 v146, v17, v21
    v_cvt_pk_bf16_f32 v147, v81, v85
    s_add_u32 s63, s90, 86016
    buffer_store_dwordx2 v[146:147], v253, s[20:23], s63 offen sc1
    v_mfma_f32_16x16x32_bf16 v[104:107], v[240:243], v[212:215], v[104:107]
    v_cvt_pk_bf16_f32 v148, v18, v22
    v_cvt_pk_bf16_f32 v149, v82, v86
    s_add_u32 s63, s90, 155648
    buffer_store_dwordx2 v[148:149], v253, s[20:23], s63 offen sc1
    v_mfma_f32_16x16x32_bf16 v[108:111], v[248:251], v[208:211], v[108:111]
    v_cvt_pk_bf16_f32 v150, v19, v23
    v_cvt_pk_bf16_f32 v151, v83, v87
    s_add_u32 s63, s90, 225280
    buffer_store_dwordx2 v[150:151], v253, s[20:23], s63 offen sc1
    v_cvt_pk_bf16_f32 v152, v24, v28
    v_cvt_pk_bf16_f32 v153, v88, v92
    s_add_u32 s63, s90, 1130496
    buffer_store_dwordx2 v[152:153], v253, s[20:23], s63 offen sc1
    v_cvt_pk_bf16_f32 v154, v25, v29
    v_cvt_pk_bf16_f32 v155, v89, v93
    s_add_u32 s63, s90, 1200128
    buffer_store_dwordx2 v[154:155], v253, s[20:23], s63 offen sc1
    v_cvt_pk_bf16_f32 v156, v26, v30
    v_cvt_pk_bf16_f32 v157, v90, v94
    s_add_u32 s63, s90, 1269760
    buffer_store_dwordx2 v[156:157], v253, s[20:23], s63 offen sc1
    v_cvt_pk_bf16_f32 v158, v27, v31
    v_cvt_pk_bf16_f32 v159, v91, v95
    s_add_u32 s63, s90, 1339392
    buffer_store_dwordx2 v[158:159], v253, s[20:23], s63 offen sc1
    v_mfma_f32_16x16x32_bf16 v[112:115], v[228:231], v[216:219], 0
    v_mfma_f32_16x16x32_bf16 v[116:119], v[228:231], v[220:223], 0
    v_mfma_f32_16x16x32_bf16 v[112:115], v[236:239], v[220:223], v[112:115]
    v_mfma_f32_16x16x32_bf16 v[116:119], v[244:247], v[216:219], v[116:119]
    v_mfma_f32_16x16x32_bf16 v[120:123], v[232:235], v[216:219], 0
    v_cvt_pk_bf16_f32 v128, v32, v36
    v_cvt_pk_bf16_f32 v129, v96, v100
    s_add_u32 s63, s90, 32768
    buffer_store_dwordx2 v[128:129], v253, s[20:23], s63 offen sc1
    v_mfma_f32_16x16x32_bf16 v[124:127], v[232:235], v[220:223], 0
    v_cvt_pk_bf16_f32 v130, v33, v37
    v_cvt_pk_bf16_f32 v131, v97, v101
    s_add_u32 s63, s90, 102400
    buffer_store_dwordx2 v[130:131], v253, s[20:23], s63 offen sc1
    v_mfma_f32_16x16x32_bf16 v[120:123], v[240:243], v[220:223], v[120:123]
    v_cvt_pk_bf16_f32 v132, v34, v38
    v_cvt_pk_bf16_f32 v133, v98, v102
    s_add_u32 s63, s90, 172032
    buffer_store_dwordx2 v[132:133], v253, s[20:23], s63 offen sc1
    v_mfma_f32_16x16x32_bf16 v[124:127], v[248:251], v[216:219], v[124:127]
    v_cvt_pk_bf16_f32 v134, v35, v39
    v_cvt_pk_bf16_f32 v135, v99, v103
    s_add_u32 s63, s90, 241664
    buffer_store_dwordx2 v[134:135], v253, s[20:23], s63 offen sc1
    v_cvt_pk_bf16_f32 v136, v40, v44
    v_cvt_pk_bf16_f32 v137, v104, v108
    s_add_u32 s63, s90, 1146880
    buffer_store_dwordx2 v[136:137], v253, s[20:23], s63 offen sc1
    v_cvt_pk_bf16_f32 v138, v41, v45
    v_cvt_pk_bf16_f32 v139, v105, v109
    s_add_u32 s63, s90, 1216512
    buffer_store_dwordx2 v[138:139], v253, s[20:23], s63 offen sc1
    v_cvt_pk_bf16_f32 v140, v42, v46
    v_cvt_pk_bf16_f32 v141, v106, v110
    s_add_u32 s63, s90, 1286144
    buffer_store_dwordx2 v[140:141], v253, s[20:23], s63 offen sc1
    v_cvt_pk_bf16_f32 v142, v43, v47
    v_cvt_pk_bf16_f32 v143, v107, v111
    s_add_u32 s63, s90, 1355776
    buffer_store_dwordx2 v[142:143], v253, s[20:23], s63 offen sc1
    v_cvt_pk_bf16_f32 v144, v48, v52
    v_cvt_pk_bf16_f32 v145, v112, v116
    s_add_u32 s63, s90, 49152
    buffer_store_dwordx2 v[144:145], v253, s[20:23], s63 offen sc1
    v_cvt_pk_bf16_f32 v146, v49, v53
    v_cvt_pk_bf16_f32 v147, v113, v117
    s_add_u32 s63, s90, 118784
    buffer_store_dwordx2 v[146:147], v253, s[20:23], s63 offen sc1
    v_cvt_pk_bf16_f32 v148, v50, v54
    v_cvt_pk_bf16_f32 v149, v114, v118
    s_add_u32 s63, s90, 188416
    buffer_store_dwordx2 v[148:149], v253, s[20:23], s63 offen sc1
    v_cvt_pk_bf16_f32 v150, v51, v55
    v_cvt_pk_bf16_f32 v151, v115, v119
    s_add_u32 s63, s90, 258048
    buffer_store_dwordx2 v[150:151], v253, s[20:23], s63 offen sc1
    v_cvt_pk_bf16_f32 v152, v56, v60
    v_cvt_pk_bf16_f32 v153, v120, v124
    s_add_u32 s63, s90, 1163264
    buffer_store_dwordx2 v[152:153], v253, s[20:23], s63 offen sc1
    v_cvt_pk_bf16_f32 v154, v57, v61
    v_cvt_pk_bf16_f32 v155, v121, v125
    s_add_u32 s63, s90, 1232896
    buffer_store_dwordx2 v[154:155], v253, s[20:23], s63 offen sc1
    v_cvt_pk_bf16_f32 v156, v58, v62
    v_cvt_pk_bf16_f32 v157, v122, v126
    s_add_u32 s63, s90, 1302528
    buffer_store_dwordx2 v[156:157], v253, s[20:23], s63 offen sc1
    v_cvt_pk_bf16_f32 v158, v59, v63
    v_cvt_pk_bf16_f32 v159, v123, v127
    s_add_u32 s63, s90, 1372160
    buffer_store_dwordx2 v[158:159], v253, s[20:23], s63 offen sc1
    s_waitcnt vmcnt(0)
    s_barrier
    s_barrier
    s_branch L_stage2_4
L_end_1:
    s_endpgm
L_code_end:
.section .rodata,"a"
.p2align 6
.amdhsa_kernel recurrent_scan__spectral_fnet__swiglu_ffn__prompt_kernel
  .amdhsa_next_free_vgpr 256
  .amdhsa_next_free_sgpr 102
  .amdhsa_accum_offset 256
  .amdhsa_group_segment_fixed_size 0
  .amdhsa_kernarg_size 96
  .amdhsa_user_sgpr_count 2
  .amdhsa_user_sgpr_kernarg_segment_ptr 1
  .amdhsa_system_sgpr_workgroup_id_x 1
  .amdhsa_float_denorm_mode_32 3
.end_amdhsa_kernel
```
